```python
import torch

def _softmax(x, axis=-1):
    return torch.softmax(x, dim=axis)
def _gelu(x):
    return torch.nn.functional.gelu(x, approximate="tanh")
def _silu(x):
    return torch.nn.functional.silu(x)
def _sigmoid(x):
    return torch.sigmoid(x)
def _layernorm(x, axis=-1, eps=1e-5):
    m = x.mean(dim=axis, keepdim=True)
    v = x.var(dim=axis, keepdim=True, unbiased=False)
    return (x - m) / torch.sqrt(v + eps)
def _scatter_add(tgt, idx, src, axis=0):
    return tgt.clone().index_add_(axis, idx, src)
def _segment_sum(src, seg, n):
    out = torch.zeros((n,) + src.shape[1:], dtype=src.dtype)
    return out.index_add_(0, seg, src)
def _pad(x, pw):
    flat = tuple(v for pair in reversed(pw) for v in pair)
    return torch.nn.functional.pad(x, flat)

kernel_name = 'gather_scatter__edge_featured_mpnn_egc__graph'

def setup_inputs():

    _w = (lambda a: (lambda t: t.to(torch.bfloat16) if t.is_floating_point() else t)(torch.as_tensor(a)))
    N, deg, D, De = 12500, 64, 64, max(16, 1)
    E = N * deg
    return {
        "x": _w((lambda *s: torch.randn(*s, dtype=torch.bfloat16) * 0.2)(N, D)),
        "e_attr": _w((lambda *s: torch.randn(*s, dtype=torch.bfloat16) * 0.2)(E, De)),
        "src": _w((lambda lo, hi, *s: torch.randint(lo, hi, s))(0, N, E).to(torch.int64)),
        "dst": _w((lambda lo, hi, *s: torch.randint(lo, hi, s))(0, N, E).to(torch.int64)),
        "u_w": _w((lambda *s: torch.randn(*s, dtype=torch.bfloat16) * 0.05)(D, D)),
        "v_w": _w((lambda *s: torch.randn(*s, dtype=torch.bfloat16) * 0.05)(D, D)),
        "g_w": _w((lambda *s: torch.randn(*s, dtype=torch.bfloat16) * 0.2)(2 * D + De, D)),
    }

def reference(x, e_attr, src, dst, u_w, v_w, g_w):
    N, D = x.shape
    g_in = torch.concatenate([x[dst], x[src], e_attr], axis=-1)
    eta = _sigmoid(g_in @ g_w)
    hv = x @ v_w
    msg = eta * hv[src]
    agg = _segment_sum(msg, dst, N)
    return _silu(x @ u_w + agg)
```

```asm
; @launch kernel=bin_kernel grid=(254,1,1) block=(832,1,1) lds=14848
; @launch kernel=gather_scatter__edge_featured_mpnn_egc__graph_kernel grid=(256,1,1) block=(512,1,1) lds=159360
.amdgcn_target "amdgcn-amd-amdhsa--gfx950"
.text
.globl bin_kernel
.p2align 8
.type bin_kernel,@function
bin_kernel:
    s_cmp_ge_u32 s2, 254
    s_cbranch_scc1 K1_end
    s_cmp_ge_u32 s2, 250
    s_cbranch_scc1 K1_weights
    s_load_dwordx4 s[4:7], s[0:1], 16
    s_load_dwordx2 s[16:17], s[0:1], 72
    s_load_dwordx2 s[36:37], s[0:1], 8
    v_lshrrev_b32 v1, 6, v0
    v_lshlrev_b32 v2, 4, v0
    v_readfirstlane_b32 s28, v1
    v_and_b32 v1, 63, v0
    s_mul_i32 s3, s2, 12800
    v_cmp_gt_u32 s[30:31], 32, v1
    s_cmp_eq_u32 s28, 12
    s_cselect_b64 s[30:31], s[30:31], -1
    s_waitcnt lgkmcnt(0)
    s_mov_b32 s8, s6
    s_mov_b32 s9, s7
    s_mov_b32 s10, 3200000
    s_mov_b32 s11, 0x20000
    s_mov_b32 s6, 3200000
    s_mov_b32 s7, 0x20000
    s_mov_b64 exec, s[30:31]
    buffer_load_dwordx4 v[32:35], v2, s[8:11], s3 offen
    buffer_load_dwordx4 v[36:39], v2, s[4:7], s3 offen
    s_mov_b64 exec, -1
    v_mov_b32 v20, 0
    v_mov_b32 v21, 0
    v_mov_b32 v22, 0
    v_mov_b32 v23, 0
    v_mov_b32 v24, 1
    v_lshlrev_b32 v3, 4, v1
    s_cmp_lg_u32 s28, 0
    s_cbranch_scc1 K1_nozero
    ds_write_b128 v3, v[20:23] offset:0
K1_nozero:
    s_mov_b32 s38, 25600000
    s_mov_b32 s39, 0x20000
    s_add_u32 s20, s16, 3200000
    s_addc_u32 s21, s17, 0
    s_mov_b32 s22, 262144
    s_mov_b32 s23, 0x20000
    s_mov_b32 s18, 3200000
    s_mov_b32 s19, 0x20000
    s_and_b32 s35, s2, 7
    s_lshl_b32 s35, s35, 5
    s_lshr_b32 s42, s2, 3
    s_or_b32 s35, s35, s42
    s_lshl_b32 s35, s35, 2
    s_lshl_b32 s42, s28, 10
    s_add_u32 s35, s35, s42
    v_lshl_add_u32 v31, v1, 12, s35
    s_mul_i32 s34, s2, 3
    s_waitcnt lgkmcnt(0)
    s_barrier
    s_sub_u32 s32, 12, s28
    s_cmp_lt_u32 s32, 3
    s_cselect_b32 s32, s32, 0x10000
    s_add_u32 s32, s32, s34
    s_lshl_b32 s32, s32, 13
    v_lshl_add_u32 v30, v1, 7, s32
    buffer_load_dword v4, v30, s[36:39], 0 offen
    s_mov_b64 exec, s[30:31]
    v_lshlrev_b32 v25, 2, v0
    s_mov_b32 s29, 0xfc000000
    s_waitcnt vmcnt(2)
    v_lshlrev_b32_sdwa v40, 2, v32 dst_sel:DWORD dst_unused:UNUSED_PAD src0_sel:DWORD src1_sel:BYTE_0
    ds_add_rtn_u32 v44, v40, v24 offset:0
    v_lshlrev_b32_sdwa v41, 2, v33 dst_sel:DWORD dst_unused:UNUSED_PAD src0_sel:DWORD src1_sel:BYTE_0
    ds_add_rtn_u32 v45, v41, v24 offset:0
    v_lshlrev_b32_sdwa v42, 2, v34 dst_sel:DWORD dst_unused:UNUSED_PAD src0_sel:DWORD src1_sel:BYTE_0
    ds_add_rtn_u32 v46, v42, v24 offset:0
    v_lshlrev_b32_sdwa v43, 2, v35 dst_sel:DWORD dst_unused:UNUSED_PAD src0_sel:DWORD src1_sel:BYTE_0
    ds_add_rtn_u32 v47, v43, v24 offset:0
    v_lshlrev_b32 v32, 18, v32
    v_and_or_b32 v32, v32, s29, v25
    v_lshlrev_b32 v33, 18, v33
    v_add_u32 v26, 1, v25
    v_and_or_b32 v33, v33, s29, v26
    v_lshlrev_b32 v34, 18, v34
    v_add_u32 v26, 2, v25
    v_and_or_b32 v34, v34, s29, v26
    v_lshlrev_b32 v35, 18, v35
    v_add_u32 v26, 3, v25
    v_and_or_b32 v35, v35, s29, v26
    s_mov_b64 exec, -1
    s_waitcnt lgkmcnt(0)
    s_barrier
    ds_read_b128 v[20:23], v3 offset:0
    s_waitcnt vmcnt(1)
    s_waitcnt lgkmcnt(0)
    v_add_u32 v9, v20, v21
    v_add_u32 v10, v9, v22
    v_add_u32 v11, v10, v23
    v_mov_b32 v26, v11
    v_lshl_or_b32 v32, v36, 12, v32
    v_lshl_or_b32 v33, v37, 12, v33
    v_add_u32_dpp v26, v26, v26 row_shr:1 row_mask:0xf bank_mask:0xf bound_ctrl:1
    v_lshl_or_b32 v34, v38, 12, v34
    v_lshl_or_b32 v35, v39, 12, v35
    v_add_u32_dpp v26, v26, v26 row_shr:2 row_mask:0xf bank_mask:0xf bound_ctrl:1
    s_nop 1
    v_add_u32_dpp v26, v26, v26 row_shr:4 row_mask:0xf bank_mask:0xf bound_ctrl:1
    s_nop 1
    v_add_u32_dpp v26, v26, v26 row_shr:8 row_mask:0xf bank_mask:0xf bound_ctrl:1
    s_nop 1
    v_add_u32_dpp v26, v26, v26 row_bcast:15 row_mask:0xa bank_mask:0xf
    s_nop 1
    v_add_u32_dpp v26, v26, v26 row_bcast:31 row_mask:0xc bank_mask:0xf
    v_sub_u32 v26, v26, v11
    v_add_u32 v27, v26, v20
    v_add_u32 v28, v26, v9
    v_add_u32 v29, v26, v10
    v_lshlrev_b32 v12, 2, v26
    v_lshlrev_b32 v13, 2, v27
    v_lshlrev_b32 v14, 2, v28
    v_lshlrev_b32 v15, 2, v29
    ds_write_b128 v3, v[12:15] offset:1024
    s_mov_b64 exec, s[30:31]
    ds_read_b32 v40, v40 offset:1024
    ds_read_b32 v41, v41 offset:1024
    ds_read_b32 v42, v42 offset:1024
    ds_read_b32 v43, v43 offset:1024
    s_waitcnt lgkmcnt(3)
    v_lshl_add_u32 v40, v44, 2, v40
    ds_write_b32 v40, v32 offset:2048
    s_waitcnt lgkmcnt(3)
    v_lshl_add_u32 v41, v45, 2, v41
    ds_write_b32 v41, v33 offset:2048
    s_waitcnt lgkmcnt(3)
    v_lshl_add_u32 v42, v46, 2, v42
    ds_write_b32 v42, v34 offset:2048
    s_waitcnt lgkmcnt(3)
    v_lshl_add_u32 v43, v47, 2, v43
    ds_write_b32 v43, v35 offset:2048
    s_mov_b64 exec, -1
    s_cmp_gt_u32 s28, 3
    s_cbranch_scc1 K1_notab
    s_cmp_eq_u32 s28, 1
    s_cselect_b64 vcc, -1, 0
    v_cndmask_b32 v20, v20, v21, vcc
    v_cndmask_b32 v26, v26, v27, vcc
    s_cmp_eq_u32 s28, 2
    s_cselect_b64 vcc, -1, 0
    v_cndmask_b32 v20, v20, v22, vcc
    v_cndmask_b32 v26, v26, v28, vcc
    s_cmp_eq_u32 s28, 3
    s_cselect_b64 vcc, -1, 0
    v_cndmask_b32 v20, v20, v23, vcc
    v_cndmask_b32 v26, v26, v29, vcc
    v_lshl_or_b32 v12, v20, 16, v26
    buffer_store_dword v12, v31, s[20:23], 0 offen
K1_notab:
    s_mov_b64 exec, s[30:31]
    s_waitcnt lgkmcnt(0)
    s_barrier
    ds_read_b128 v[32:35], v2 offset:2048
    s_waitcnt lgkmcnt(0)
    buffer_store_dwordx4 v[32:35], v2, s[16:19], s3 offen
    s_mov_b64 exec, -1
    s_endpgm
K1_weights:
    s_load_dwordx4 s[4:7], s[0:1], 32
    s_load_dwordx2 s[8:9], s[0:1], 48
    s_load_dwordx2 s[16:17], s[0:1], 72
    v_lshrrev_b32 v1, 6, v0
    s_nop 0
    v_readfirstlane_b32 s28, v1
    s_sub_u32 s3, s2, 250
    s_mul_i32 s3, s3, 13
    s_add_u32 s3, s3, s28
    s_cmp_ge_u32 s3, 40
    s_cbranch_scc1 K1_end
    v_and_b32 v1, 63, v0
    s_waitcnt lgkmcnt(0)
    s_add_u32 s16, s16, 3462144
    s_addc_u32 s17, s17, 0
    s_mov_b32 s18, 40960
    s_mov_b32 s19, 0x20000
    s_lshl_b32 s35, s3, 10
    v_lshlrev_b32 v20, 4, v1
    s_cmp_ge_u32 s3, 34
    s_cbranch_scc1 K1_consts
    s_mov_b32 s12, s8
    s_mov_b32 s13, s9
    s_mov_b32 s14, 18432
    s_mov_b32 s15, 0x20000
    s_mov_b32 s29, 64
    s_mov_b32 s30, s3
    s_mov_b32 s31, 0xbfb8aa3b
    s_cmp_lt_u32 s3, 8
    s_cbranch_scc1 K1_wgo
    s_mov_b32 s29, 128
    s_sub_u32 s30, s3, 16
    s_lshl_b32 s30, s30, 2
    s_and_b32 s32, s3, 0xfe
    s_cmp_eq_u32 s32, 16
    s_cbranch_scc1 K1_wgo
    s_mov_b32 s29, 0
    s_mov_b32 s31, 1.0
    s_sub_u32 s30, s3, 18
    s_cmp_lt_u32 s30, 8
    s_cbranch_scc1 K1_wgo
    s_mov_b32 s14, 8192
    s_mov_b32 s12, s6
    s_mov_b32 s13, s7
    s_sub_u32 s30, s3, 8
    s_cmp_lt_u32 s3, 16
    s_cbranch_scc1 K1_wgo
    s_mov_b32 s12, s4
    s_mov_b32 s13, s5
    s_sub_u32 s30, s3, 26
K1_wgo:
    s_and_b32 s32, s30, 3
    s_lshl_b32 s32, s32, 4
    s_add_u32 s32, s32, s29
    s_lshl_b32 s32, s32, 7
    s_lshr_b32 s33, s30, 2
    s_lshl_b32 s33, s33, 6
    s_add_u32 s32, s32, s33
    v_lshrrev_b32 v2, 5, v1
    v_lshlrev_b32 v2, 10, v2
    v_and_b32 v3, 31, v1
    v_lshl_add_u32 v2, v3, 1, v2
    buffer_load_ushort v4, v2, s[12:15], s32 offen offset:0
    buffer_load_ushort v5, v2, s[12:15], s32 offen offset:128
    buffer_load_ushort v6, v2, s[12:15], s32 offen offset:256
    buffer_load_ushort v7, v2, s[12:15], s32 offen offset:384
    buffer_load_ushort v8, v2, s[12:15], s32 offen offset:512
    buffer_load_ushort v9, v2, s[12:15], s32 offen offset:640
    buffer_load_ushort v10, v2, s[12:15], s32 offen offset:768
    buffer_load_ushort v11, v2, s[12:15], s32 offen offset:896
    s_waitcnt vmcnt(0)
    v_lshlrev_b32 v4, 16, v4
    v_mul_f32 v4, s31, v4
    v_lshlrev_b32 v5, 16, v5
    v_mul_f32 v5, s31, v5
    v_lshlrev_b32 v6, 16, v6
    v_mul_f32 v6, s31, v6
    v_lshlrev_b32 v7, 16, v7
    v_mul_f32 v7, s31, v7
    v_lshlrev_b32 v8, 16, v8
    v_mul_f32 v8, s31, v8
    v_lshlrev_b32 v9, 16, v9
    v_mul_f32 v9, s31, v9
    v_lshlrev_b32 v10, 16, v10
    v_mul_f32 v10, s31, v10
    v_lshlrev_b32 v11, 16, v11
    v_mul_f32 v11, s31, v11
    v_cvt_pk_bf16_f32 v12, v4, v5
    v_cvt_pk_bf16_f32 v13, v6, v7
    v_cvt_pk_bf16_f32 v14, v8, v9
    v_cvt_pk_bf16_f32 v15, v10, v11
K1_wstore:
    buffer_store_dwordx4 v[12:15], v20, s[16:19], s35 offen
K1_end:
    s_endpgm
K1_consts:
    v_lshrrev_b32 v2, 5, v1
    v_and_b32 v3, 31, v1
    s_cmp_eq_u32 s3, 35
    s_cbranch_scc1 K1_c35
    s_cmp_eq_u32 s3, 36
    s_cbranch_scc1 K1_c36
    s_cmp_eq_u32 s3, 37
    s_cbranch_scc1 K1_c37
    s_cmp_eq_u32 s3, 38
    s_cbranch_scc1 K1_c38
    s_cmp_eq_u32 s3, 39
    s_cbranch_scc1 K1_c39
    v_mov_b32 v12, 0
    v_mov_b32 v14, 0
    v_and_b32 v4, 7, v1
    v_lshlrev_b32 v5, 2, v2
    v_xor_b32 v4, v4, v5
    v_lshlrev_b32 v4, 4, v4
    v_xor_b32 v4, 0, v4
    v_add_u32 v13, 3072, v4
    v_and_b32 v4, 7, v1
    v_lshlrev_b32 v5, 2, v2
    v_xor_b32 v4, v4, v5
    v_lshlrev_b32 v4, 4, v4
    v_xor_b32 v4, 16, v4
    v_add_u32 v15, 2048, v4
    s_branch K1_wstore
K1_c35:
    v_mov_b32 v12, 0
    v_mov_b32 v14, 0
    v_and_b32 v4, 7, v1
    v_lshlrev_b32 v5, 2, v2
    v_xor_b32 v4, v4, v5
    v_lshlrev_b32 v4, 4, v4
    v_xor_b32 v4, 32, v4
    v_add_u32 v13, 1024, v4
    v_and_b32 v4, 7, v1
    v_lshlrev_b32 v5, 2, v2
    v_xor_b32 v4, v4, v5
    v_lshlrev_b32 v4, 4, v4
    v_xor_b32 v4, 48, v4
    v_add_u32 v15, 0, v4
    s_branch K1_wstore
K1_c36:
    v_mov_b32 v12, 0
    v_and_b32 v4, 1, v1
    v_xor_b32 v4, v4, v2
    v_lshlrev_b32 v13, 4, v4
    v_bfe_u32 v4, v1, 4, 1
    v_lshlrev_b32 v4, 5, v4
    v_and_b32 v5, 3, v1
    v_lshl_add_u32 v14, v5, 3, v4
    v_lshlrev_b32 v4, 3, v3
    v_add_u32 v15, 0x80000000, v4
    s_branch K1_wstore
K1_c37:
    v_bfe_u32 v4, v1, 3, 2
    v_lshlrev_b32 v4, 5, v4
    v_add_u32 v12, 82944, v4
    v_lshrrev_b32 v4, 4, v1
    v_lshlrev_b32 v4, 2, v4
    v_bfe_u32 v5, v1, 1, 2
    v_add_lshl_u32 v4, v4, v5, 3
    v_add_u32 v13, 82944, v4
    v_bfe_u32 v4, v1, 2, 2
    v_lshlrev_b32 v4, 2, v4
    v_add_u32 v14, 111616, v4
    v_lshrrev_b32 v4, 1, v3
    v_and_b32 v4, 7, v4
    v_xor_b32 v4, v4, v2
    v_lshlrev_b32 v4, 4, v4
    v_lshl_add_u32 v4, v3, 7, v4
    v_add_u32 v15, 151168, v4
    s_branch K1_wstore
K1_c38:
    v_and_b32 v4, 3, v3
    v_lshlrev_b32 v4, 3, v4
    v_and_b32 v5, 4, v3
    v_or_b32 v4, v4, v5
    v_lshrrev_b32 v5, 3, v3
    v_or_b32 v4, v4, v5
    v_lshlrev_b32 v4, 7, v4
    v_and_b32 v5, 7, v3
    v_xor_b32 v5, v5, v2
    v_lshlrev_b32 v5, 4, v5
    v_xor_b32 v6, 0, v5
    v_add_u32 v12, v4, v6
    v_xor_b32 v6, 32, v5
    v_add_u32 v13, v4, v6
    v_xor_b32 v6, 64, v5
    v_add_u32 v14, v4, v6
    v_xor_b32 v6, 96, v5
    v_add_u32 v15, v4, v6
    s_branch K1_wstore
K1_c39:
    v_bfe_u32 v4, v3, 2, 1
    v_cmp_eq_u32 vcc, v4, v2
    v_bfe_u32 v5, v3, 3, 1
    v_lshlrev_b32 v5, 4, v5
    v_mov_b32 v6, 0x3f80
    v_lshlrev_b32 v6, v5, v6
    v_cndmask_b32 v6, 0, v6, vcc
    v_cmp_gt_u32 vcc, 16, v3
    v_mov_b32 v14, 0
    v_lshrrev_b32 v4, 4, v3
    v_xor_b32 v4, v4, v2
    v_lshlrev_b32 v4, 4, v4
    v_lshl_add_u32 v4, v3, 5, v4
    v_add_u32 v15, 4096, v4
    v_cndmask_b32 v12, 0, v6, vcc
    v_cndmask_b32 v13, v6, v14, vcc
    s_branch K1_wstore
.globl gather_scatter__edge_featured_mpnn_egc__graph_kernel
.p2align 8
.type gather_scatter__edge_featured_mpnn_egc__graph_kernel,@function
gather_scatter__edge_featured_mpnn_egc__graph_kernel:
    s_cmp_ge_u32 s2, 256
    s_cbranch_scc1 K2_end
    s_load_dwordx4 s[4:7], s[0:1], 0
    s_load_dwordx2 s[24:25], s[0:1], 56
    s_load_dwordx2 s[16:17], s[0:1], 72
    v_lshrrev_b32 v2, 6, v0
    v_and_b32 v1, 63, v0
    v_readfirstlane_b32 s28, v2
    s_and_b32 s3, s2, 7
    s_lshl_b32 s3, s3, 5
    s_lshr_b32 s29, s2, 3
    s_or_b32 s29, s29, s3
    v_lshrrev_b32 v9, 1, v0
    s_lshl_b32 s3, s29, 10
    v_lshl_add_u32 v2, v9, 2, s3
    s_waitcnt lgkmcnt(0)
    s_add_u32 s20, s16, 3200000
    s_addc_u32 s21, s17, 0
    s_mov_b32 s22, 262144
    s_mov_b32 s23, 0x20000
    buffer_load_dword v2, v2, s[20:23], 0 offen
    v_mov_b32 v16, 0
    v_mov_b32 v17, 0
    v_mov_b32 v18, 0
    v_mov_b32 v19, 0
    v_lshlrev_b32 v8, 4, v0
    v_add_u32 v5, 115328, v8
    ds_write_b128 v5, v[16:19] offset:0
    ds_write_b128 v5, v[16:19] offset:8192
    ds_write_b128 v5, v[16:19] offset:16384
    ds_write_b128 v5, v[16:19] offset:24576
    v_mov_b32 v11, 0
    v_lshlrev_b32 v12, 2, v1
    v_mov_b32 v13, 1
    s_cmp_lg_u32 s28, 0
    s_cbranch_scc1 L_nz
    ds_write_b32 v12, v11 offset:0
    ds_write_b32 v12, v11 offset:512
L_nz:
    s_mov_b32 s12, s6
    s_mov_b32 s13, s7
    s_mov_b32 s14, 25600000
    s_mov_b32 s15, 0x20000
    s_mov_b32 s6, 1600000
    s_mov_b32 s7, 0x20000
    s_add_u32 s52, s16, 3462144
    s_addc_u32 s53, s17, 0
    s_mov_b32 s54, 40960
    s_mov_b32 s55, 0x20000
    s_mov_b32 s18, 3200000
    s_mov_b32 s19, 0x20000
    s_mul_i32 s38, s28, 10240
    s_add_u32 s38, s38, 1024
    s_lshl_b32 s31, s28, 2
    v_lshrrev_b32 v10, 4, v1
    v_add_u32 v10, s31, v10
    v_xor_b32 v10, v10, v1
    v_and_b32 v10, 7, v10
    v_lshlrev_b32 v10, 4, v10
    v_lshrrev_b32 v4, 3, v0
    v_lshl_add_u32 v10, v4, 15, v10
    s_lshl_b32 s3, s29, 7
    v_add_u32 v10, s3, v10
    v_and_b32 v4, 31, v9
    v_lshrrev_b32 v9, 5, v9
    v_lshl_or_b32 v4, v4, 3, v9
    s_movk_i32 s48, 250
    v_cmp_gt_u32 s[46:47], s48, v4
    v_mul_u32_u24 v4, 3200, v4
    v_and_b32 v9, 1, v0
    v_cmp_eq_u32 vcc, 1, v9
    s_waitcnt vmcnt(0)
    v_cndmask_b32 v2, 0, v2, s[46:47]
    v_lshrrev_b32 v3, 16, v2
    v_and_b32 v5, 0xffff, v2
    v_add_u32 v5, v5, v4
    v_add_u32 v6, 1, v3
    v_lshrrev_b32 v6, 1, v6
    v_sub_u32 v7, v3, v6
    v_cndmask_b32 v7, v6, v7, vcc
    v_cndmask_b32 v6, 0, v6, vcc
    v_min_u32 v7, 20, v7
    v_add_u32 v6, v6, v5
    v_lshlrev_b32 v8, 2, v6
    v_cmpx_lt_u32 vcc, 0, v7
    s_cbranch_execz L_ld_f
    buffer_load_dwordx4 v[16:19], v8, s[16:19], 0 offen offset:0
    v_cmpx_lt_u32 vcc, 4, v7
    s_cbranch_execz L_ld_f
    buffer_load_dwordx4 v[20:23], v8, s[16:19], 0 offen offset:16
    v_cmpx_lt_u32 vcc, 8, v7
    s_cbranch_execz L_ld_f
    buffer_load_dwordx4 v[24:27], v8, s[16:19], 0 offen offset:32
    v_cmpx_lt_u32 vcc, 12, v7
    s_cbranch_execz L_ld_f
    buffer_load_dwordx4 v[28:31], v8, s[16:19], 0 offen offset:48
    v_cmpx_lt_u32 vcc, 16, v7
    s_cbranch_execz L_ld_f
    buffer_load_dwordx4 v[32:35], v8, s[16:19], 0 offen offset:64
L_ld_f:
    s_mov_b64 exec, -1
    s_waitcnt lgkmcnt(0)
    s_barrier
    s_cmp_ge_u32 s28, 4
    s_cbranch_scc1 L_nostage
    v_lshlrev_b32 v8, 4, v0
    s_add_u32 m0, s38, 9216
    v_add_u32 v2, 32768, v8
    buffer_load_dwordx4 v2, s[52:55], 0 offen lds
    s_add_u32 m0, s38, 50176
    v_add_u32 v2, 36864, v8
    buffer_load_dwordx4 v2, s[52:55], 0 offen lds
    s_lshl_b32 s47, s28, 10
    s_add_u32 m0, s47, 151168
    v_add_u32 v2, 1048576, v10
    buffer_load_dwordx4 v10, s[4:7], 0 offen lds
    s_add_u32 m0, s47, 155264
    s_nop 0
    buffer_load_dwordx4 v2, s[4:7], 0 offen lds
    s_add_u32 m0, s38, 7168
    v_add_u32 v2, 16384, v8
    buffer_load_dwordx4 v2, s[52:55], 0 offen lds
    s_add_u32 m0, s38, 48128
    v_add_u32 v2, 20480, v8
    buffer_load_dwordx4 v2, s[52:55], 0 offen lds
    s_add_u32 m0, s38, 8192
    v_add_u32 v2, 24576, v8
    buffer_load_dwordx4 v2, s[52:55], 0 offen lds
    s_add_u32 m0, s38, 49152
    v_add_u32 v2, 28672, v8
    buffer_load_dwordx4 v2, s[52:55], 0 offen lds
    s_add_u32 m0, s38, 5120
    v_add_u32 v2, 0, v8
    buffer_load_dwordx4 v2, s[52:55], 0 offen lds
    s_add_u32 m0, s38, 46080
    v_add_u32 v2, 4096, v8
    buffer_load_dwordx4 v2, s[52:55], 0 offen lds
    s_add_u32 m0, s38, 6144
    v_add_u32 v2, 8192, v8
    buffer_load_dwordx4 v2, s[52:55], 0 offen lds
    s_add_u32 m0, s38, 47104
    v_add_u32 v2, 12288, v8
    buffer_load_dwordx4 v2, s[52:55], 0 offen lds
L_nostage:
    v_lshlrev_b32 v10, 4, v1
    v_cmp_lt_u32 vcc, 40, v3
    s_cbranch_vccz L_noflag
    ds_write_b32 v11, v13 offset:512
L_noflag:
    s_sub_u32 s8, s4, 3072
    s_subb_u32 s9, s5, 0
    s_or_b32 s9, s9, 8388608
    s_mov_b32 s10, 0
    s_mov_b32 s11, 0x20000
    s_mov_b32 s56, s12
    s_or_b32 s57, s13, 2097152
    s_mov_b32 s58, 0
    s_mov_b32 s59, 0x20000
    s_mov_b32 s26, 1600000
    s_mov_b32 s27, 0x20000
    s_mov_b32 s41, 12500
    s_mov_b32 s42, 800000
    s_mov_b32 s43, 0x3ff80
    s_mov_b32 s44, 0xfc
    s_mov_b32 s40, 0
    s_mov_b32 s39, 0
    s_mov_b32 s50, 1
    s_mov_b32 s51, 0
    v_lshrrev_b32 v14, 5, v1
    v_and_b32 v15, 31, v1
    v_add_u32 v255, 40960, v10
    v_mov_b32 v56, 0
    v_mov_b32 v57, 0
    v_mov_b32 v58, 0
    v_mov_b32 v59, 0
    v_mov_b32 v60, 0
    v_mov_b32 v61, 0
    v_mov_b32 v62, 0
    v_mov_b32 v63, 0
    v_mov_b32 v64, 0
    v_mov_b32 v65, 0
    v_mov_b32 v66, 0
    v_mov_b32 v67, 0
    v_mov_b32 v144, 0x3e803e80
    v_mov_b32 v145, 0x3e803e80
    v_mov_b32 v146, 0x3f003f00
    v_mov_b32 v147, 0x3f003f00
    s_cmp_ge_u32 s28, 4
    s_cbranch_scc0 L_wa
    s_waitcnt vmcnt(0)
L_wa:
    s_waitcnt vmcnt(12)
L_count:
    v_cmpx_lt_u32 vcc, 0, v7
    v_and_b32_sdwa v56, s44, v16 dst_sel:DWORD dst_unused:UNUSED_PAD src0_sel:DWORD src1_sel:BYTE_3
    ds_add_rtn_u32 v36, v56, v13 offset:0
    v_cmpx_lt_u32 vcc, 1, v7
    v_and_b32_sdwa v57, s44, v17 dst_sel:DWORD dst_unused:UNUSED_PAD src0_sel:DWORD src1_sel:BYTE_3
    ds_add_rtn_u32 v37, v57, v13 offset:0
    v_cmpx_lt_u32 vcc, 2, v7
    v_and_b32_sdwa v58, s44, v18 dst_sel:DWORD dst_unused:UNUSED_PAD src0_sel:DWORD src1_sel:BYTE_3
    ds_add_rtn_u32 v38, v58, v13 offset:0
    v_cmpx_lt_u32 vcc, 3, v7
    v_and_b32_sdwa v59, s44, v19 dst_sel:DWORD dst_unused:UNUSED_PAD src0_sel:DWORD src1_sel:BYTE_3
    ds_add_rtn_u32 v39, v59, v13 offset:0
    v_cmpx_lt_u32 vcc, 4, v7
    s_cbranch_execz L_cdone
    v_and_b32_sdwa v60, s44, v20 dst_sel:DWORD dst_unused:UNUSED_PAD src0_sel:DWORD src1_sel:BYTE_3
    ds_add_rtn_u32 v40, v60, v13 offset:0
    v_cmpx_lt_u32 vcc, 5, v7
    v_and_b32_sdwa v61, s44, v21 dst_sel:DWORD dst_unused:UNUSED_PAD src0_sel:DWORD src1_sel:BYTE_3
    ds_add_rtn_u32 v41, v61, v13 offset:0
    v_cmpx_lt_u32 vcc, 6, v7
    s_cbranch_execz L_cdone
    v_and_b32_sdwa v62, s44, v22 dst_sel:DWORD dst_unused:UNUSED_PAD src0_sel:DWORD src1_sel:BYTE_3
    ds_add_rtn_u32 v42, v62, v13 offset:0
    v_cmpx_lt_u32 vcc, 7, v7
    v_and_b32_sdwa v63, s44, v23 dst_sel:DWORD dst_unused:UNUSED_PAD src0_sel:DWORD src1_sel:BYTE_3
    ds_add_rtn_u32 v43, v63, v13 offset:0
    v_cmpx_lt_u32 vcc, 8, v7
    s_cbranch_execz L_cdone
    v_and_b32_sdwa v64, s44, v24 dst_sel:DWORD dst_unused:UNUSED_PAD src0_sel:DWORD src1_sel:BYTE_3
    ds_add_rtn_u32 v44, v64, v13 offset:0
    v_cmpx_lt_u32 vcc, 9, v7
    v_and_b32_sdwa v65, s44, v25 dst_sel:DWORD dst_unused:UNUSED_PAD src0_sel:DWORD src1_sel:BYTE_3
    ds_add_rtn_u32 v45, v65, v13 offset:0
    v_cmpx_lt_u32 vcc, 10, v7
    s_cbranch_execz L_cdone
    v_and_b32_sdwa v66, s44, v26 dst_sel:DWORD dst_unused:UNUSED_PAD src0_sel:DWORD src1_sel:BYTE_3
    ds_add_rtn_u32 v46, v66, v13 offset:0
    v_cmpx_lt_u32 vcc, 11, v7
    v_and_b32_sdwa v67, s44, v27 dst_sel:DWORD dst_unused:UNUSED_PAD src0_sel:DWORD src1_sel:BYTE_3
    ds_add_rtn_u32 v47, v67, v13 offset:0
    v_cmpx_lt_u32 vcc, 12, v7
    s_cbranch_execz L_cdone
    v_and_b32_sdwa v68, s44, v28 dst_sel:DWORD dst_unused:UNUSED_PAD src0_sel:DWORD src1_sel:BYTE_3
    ds_add_rtn_u32 v48, v68, v13 offset:0
    v_bfe_u32 v100, v28, 12, 14
    v_and_b32 v28, 0xfff, v28
    v_add_u32 v101, v28, v4
    v_cmpx_lt_u32 vcc, 13, v7
    v_and_b32_sdwa v69, s44, v29 dst_sel:DWORD dst_unused:UNUSED_PAD src0_sel:DWORD src1_sel:BYTE_3
    ds_add_rtn_u32 v49, v69, v13 offset:0
    v_bfe_u32 v102, v29, 12, 14
    v_and_b32 v29, 0xfff, v29
    v_add_u32 v103, v29, v4
    v_cmpx_lt_u32 vcc, 14, v7
    s_cbranch_execz L_cdone
    v_and_b32_sdwa v70, s44, v30 dst_sel:DWORD dst_unused:UNUSED_PAD src0_sel:DWORD src1_sel:BYTE_3
    ds_add_rtn_u32 v50, v70, v13 offset:0
    v_bfe_u32 v104, v30, 12, 14
    v_and_b32 v30, 0xfff, v30
    v_add_u32 v105, v30, v4
    v_cmpx_lt_u32 vcc, 15, v7
    v_and_b32_sdwa v71, s44, v31 dst_sel:DWORD dst_unused:UNUSED_PAD src0_sel:DWORD src1_sel:BYTE_3
    ds_add_rtn_u32 v51, v71, v13 offset:0
    v_bfe_u32 v106, v31, 12, 14
    v_and_b32 v31, 0xfff, v31
    v_add_u32 v107, v31, v4
    v_cmpx_lt_u32 vcc, 16, v7
    s_cbranch_execz L_cdone
    v_and_b32_sdwa v72, s44, v32 dst_sel:DWORD dst_unused:UNUSED_PAD src0_sel:DWORD src1_sel:BYTE_3
    ds_add_rtn_u32 v52, v72, v13 offset:0
    v_bfe_u32 v108, v32, 12, 14
    v_and_b32 v32, 0xfff, v32
    v_add_u32 v109, v32, v4
    v_cmpx_lt_u32 vcc, 17, v7
    v_and_b32_sdwa v73, s44, v33 dst_sel:DWORD dst_unused:UNUSED_PAD src0_sel:DWORD src1_sel:BYTE_3
    ds_add_rtn_u32 v53, v73, v13 offset:0
    v_bfe_u32 v110, v33, 12, 14
    v_and_b32 v33, 0xfff, v33
    v_add_u32 v111, v33, v4
    v_cmpx_lt_u32 vcc, 18, v7
    s_cbranch_execz L_cdone
    v_and_b32_sdwa v74, s44, v34 dst_sel:DWORD dst_unused:UNUSED_PAD src0_sel:DWORD src1_sel:BYTE_3
    ds_add_rtn_u32 v54, v74, v13 offset:0
    v_bfe_u32 v112, v34, 12, 14
    v_and_b32 v34, 0xfff, v34
    v_add_u32 v113, v34, v4
    v_cmpx_lt_u32 vcc, 19, v7
    v_and_b32_sdwa v75, s44, v35 dst_sel:DWORD dst_unused:UNUSED_PAD src0_sel:DWORD src1_sel:BYTE_3
    ds_add_rtn_u32 v55, v75, v13 offset:0
    v_bfe_u32 v114, v35, 12, 14
    v_and_b32 v35, 0xfff, v35
    v_add_u32 v115, v35, v4
L_cdone:
    s_mov_b64 exec, -1
    v_bfe_u32 v76, v16, 12, 14
    v_and_b32 v16, 0xfff, v16
    v_add_u32 v77, v16, v4
    v_bfe_u32 v78, v17, 12, 14
    v_and_b32 v17, 0xfff, v17
    v_add_u32 v79, v17, v4
    v_bfe_u32 v80, v18, 12, 14
    v_and_b32 v18, 0xfff, v18
    v_add_u32 v81, v18, v4
    s_waitcnt vmcnt(10) lgkmcnt(0)
    s_barrier
    ds_read_b32 v220, v12 offset:0
    ds_read_b32 v221, v11 offset:512
    s_cmp_lg_u32 s40, 0
    s_cbranch_scc1 L_nopf
    ds_read_b128 v[240:243], v255 offset:20480
    ds_read_b128 v[236:239], v255 offset:10240
    ds_read_b128 v[228:231], v10 offset:30720
    ds_read_b128 v[232:235], v10 offset:40960
    ds_read_b128 v[244:247], v255 offset:30720
    ds_read_b128 v[140:143], v255 offset:40960
    s_mul_i32 s48, s2, 2
    s_sub_u32 s49, 7, s28
    s_add_u32 s48, s48, s49
    s_add_u32 s48, s48, 750
    s_cmp_lt_u32 s49, 2
    s_cselect_b32 s48, s48, 0x10000
    s_lshl_b32 s48, s48, 13
    v_lshl_add_u32 v2, v1, 7, s48
    buffer_load_dword v224, v2, s[12:15], 0 offen
    v_bfe_u32 v82, v19, 12, 14
    v_and_b32 v19, 0xfff, v19
    v_add_u32 v83, v19, v4
    v_bfe_u32 v84, v20, 12, 14
    v_and_b32 v20, 0xfff, v20
    v_add_u32 v85, v20, v4
    v_bfe_u32 v86, v21, 12, 14
    v_and_b32 v21, 0xfff, v21
    v_add_u32 v87, v21, v4
    s_waitcnt lgkmcnt(6)
    s_branch L_pfd
L_nopf:
    v_bfe_u32 v82, v19, 12, 14
    v_and_b32 v19, 0xfff, v19
    v_add_u32 v83, v19, v4
    v_bfe_u32 v84, v20, 12, 14
    v_and_b32 v20, 0xfff, v20
    v_add_u32 v85, v20, v4
    v_bfe_u32 v86, v21, 12, 14
    v_and_b32 v21, 0xfff, v21
    v_add_u32 v87, v21, v4
    s_waitcnt lgkmcnt(0)
L_pfd:
    v_add_u32 v222, 3, v220
    v_lshrrev_b32 v222, 2, v222
    v_mov_b32 v223, v222
    v_readfirstlane_b32 s46, v221
    v_bfe_u32 v88, v22, 12, 14
    v_and_b32 v22, 0xfff, v22
    v_add_u32_dpp v223, v223, v223 row_shr:1 row_mask:0xf bank_mask:0xf bound_ctrl:1
    v_add_u32 v89, v22, v4
    v_bfe_u32 v90, v23, 12, 14
    v_add_u32_dpp v223, v223, v223 row_shr:2 row_mask:0xf bank_mask:0xf bound_ctrl:1
    v_and_b32 v23, 0xfff, v23
    v_add_u32 v91, v23, v4
    v_add_u32_dpp v223, v223, v223 row_shr:4 row_mask:0xf bank_mask:0xf bound_ctrl:1
    v_bfe_u32 v92, v24, 12, 14
    v_and_b32 v24, 0xfff, v24
    v_add_u32_dpp v223, v223, v223 row_shr:8 row_mask:0xf bank_mask:0xf bound_ctrl:1
    v_add_u32 v93, v24, v4
    v_bfe_u32 v94, v25, 12, 14
    v_add_u32_dpp v223, v223, v223 row_bcast:15 row_mask:0xa bank_mask:0xf
    v_and_b32 v25, 0xfff, v25
    v_add_u32 v95, v25, v4
    v_add_u32_dpp v223, v223, v223 row_bcast:31 row_mask:0xc bank_mask:0xf
    v_bfe_u32 v96, v26, 12, 14
    v_readlane_b32 s47, v223, 63
    v_sub_u32 v223, v223, v222
    v_lshlrev_b32 v225, 5, v223
    v_add_u32 v225, 82944, v225
    ds_write_b32 v12, v225 offset:256
    s_mov_b32 s3, s47
    s_add_u32 s45, s47, 7
    s_lshr_b32 s45, s45, 3
    s_cmp_gt_u32 s45, 112
    s_cselect_b32 s46, 1, s46
    s_andn2_b32 s46, s46, s40
    s_cmp_lg_u32 s46, 0
    s_cbranch_scc1 L_fb_enter
    ds_read_b32 v56, v56 offset:256
    ds_read_b32 v57, v57 offset:256
    ds_read_b32 v58, v58 offset:256
    ds_read_b32 v59, v59 offset:256
    ds_read_b32 v60, v60 offset:256
    ds_read_b32 v61, v61 offset:256
    ds_read_b32 v62, v62 offset:256
    ds_read_b32 v63, v63 offset:256
    ds_read_b32 v64, v64 offset:256
    ds_read_b32 v65, v65 offset:256
    ds_read_b32 v66, v66 offset:256
    ds_read_b32 v67, v67 offset:256
    v_cmpx_lt_u32 vcc, 12, v7
    s_cbranch_execz L_bdone
    ds_read_b32 v68, v68 offset:256
    ds_read_b32 v69, v69 offset:256
    v_cmpx_lt_u32 vcc, 14, v7
    s_cbranch_execz L_bdone
    ds_read_b32 v70, v70 offset:256
    ds_read_b32 v71, v71 offset:256
    v_cmpx_lt_u32 vcc, 16, v7
    s_cbranch_execz L_bdone
    ds_read_b32 v72, v72 offset:256
    ds_read_b32 v73, v73 offset:256
    v_cmpx_lt_u32 vcc, 18, v7
    s_cbranch_execz L_bdone
    ds_read_b32 v74, v74 offset:256
    ds_read_b32 v75, v75 offset:256
L_bdone:
    s_mov_b64 exec, -1
    v_and_b32 v26, 0xfff, v26
    v_add_u32 v97, v26, v4
    v_bfe_u32 v98, v27, 12, 14
    v_and_b32 v27, 0xfff, v27
    v_add_u32 v99, v27, v4
    s_waitcnt lgkmcnt(13)
    v_mov_b32 v252, 0x3fff
    v_mov_b32 v253, 0x7ffffff
    s_cmp_gt_u32 s28, 2
    s_cbranch_scc1 L_pad3
    v_add_u32 v2, s28, v220
    v_lshlrev_b32 v8, 2, v222
    v_cmpx_lt_u32 vcc, v2, v8
    v_lshl_add_u32 v2, v2, 3, v225
    ds_write_b64 v2, v[252:253]
    s_branch L_paddone
L_pad3:
    s_cmp_eq_u32 s28, 3
    s_cbranch_scc0 L_paddone
    s_lshl_b32 s46, s45, 5
    s_lshl_b32 s48, s47, 2
    s_sub_u32 s46, s46, s48
    s_lshl_b32 s48, s47, 5
    s_add_u32 s48, s48, 82944
    v_cmpx_gt_u32 vcc, s46, v1
    v_lshl_add_u32 v2, v1, 3, s48
    ds_write_b64 v2, v[252:253]
L_paddone:
    s_mov_b64 exec, -1
    s_and_b32 s31, s28, 3
    s_lshr_b32 s46, s45, 2
    s_and_b32 s47, s45, 3
    s_mul_i32 s48, s46, s31
    s_min_u32 s49, s47, s31
    s_add_u32 s48, s48, s49
    s_cmp_lt_u32 s31, s47
    s_addc_u32 s46, s46, 0
    s_mul_i32 s47, s46, 37
    s_add_u32 s47, s47, 32
    s_lshr_b32 s47, s47, 6
    s_sub_u32 s46, s46, s47
    s_cmp_lt_u32 s28, 4
    s_cselect_b32 s30, s47, s46
    s_cselect_b32 s47, 0, s47
    s_add_u32 s48, s48, s47
    s_lshl_b32 s46, s30, 7
    s_lshl_b32 s47, s48, 8
    v_mad_u32_u24 v249, v14, s46, v240
    v_add_u32 v249, s47, v249
    v_bfe_u32 v2, v1, 3, 1
    v_mad_u32_u24 v250, v2, s46, v241
    v_add_u32 v250, s47, v250
    s_lshl_b32 s46, s30, 4
    s_lshl_b32 s47, s48, 5
    v_mad_u32_u24 v251, v14, s46, v242
    v_add_u32 v251, s47, v251
    s_waitcnt lgkmcnt(0)
    v_cmpx_lt_u32 vcc, 0, v7
    v_lshl_add_u32 v56, v36, 3, v56
    ds_write_b64 v56, v[76:77]
    v_cmpx_lt_u32 vcc, 1, v7
    v_lshl_add_u32 v57, v37, 3, v57
    ds_write_b64 v57, v[78:79]
    v_cmpx_lt_u32 vcc, 2, v7
    v_lshl_add_u32 v58, v38, 3, v58
    ds_write_b64 v58, v[80:81]
    v_cmpx_lt_u32 vcc, 3, v7
    v_lshl_add_u32 v59, v39, 3, v59
    ds_write_b64 v59, v[82:83]
    v_cmpx_lt_u32 vcc, 4, v7
    s_cbranch_execz L_pdone
    v_lshl_add_u32 v60, v40, 3, v60
    ds_write_b64 v60, v[84:85]
    v_cmpx_lt_u32 vcc, 5, v7
    v_lshl_add_u32 v61, v41, 3, v61
    ds_write_b64 v61, v[86:87]
    v_cmpx_lt_u32 vcc, 6, v7
    s_cbranch_execz L_pdone
    v_lshl_add_u32 v62, v42, 3, v62
    ds_write_b64 v62, v[88:89]
    v_cmpx_lt_u32 vcc, 7, v7
    v_lshl_add_u32 v63, v43, 3, v63
    ds_write_b64 v63, v[90:91]
    v_cmpx_lt_u32 vcc, 8, v7
    s_cbranch_execz L_pdone
    v_lshl_add_u32 v64, v44, 3, v64
    ds_write_b64 v64, v[92:93]
    v_cmpx_lt_u32 vcc, 9, v7
    v_lshl_add_u32 v65, v45, 3, v65
    ds_write_b64 v65, v[94:95]
    v_cmpx_lt_u32 vcc, 10, v7
    s_cbranch_execz L_pdone
    v_lshl_add_u32 v66, v46, 3, v66
    ds_write_b64 v66, v[96:97]
    v_cmpx_lt_u32 vcc, 11, v7
    v_lshl_add_u32 v67, v47, 3, v67
    ds_write_b64 v67, v[98:99]
    v_cmpx_lt_u32 vcc, 12, v7
    s_cbranch_execz L_pdone
    v_lshl_add_u32 v68, v48, 3, v68
    ds_write_b64 v68, v[100:101]
    v_cmpx_lt_u32 vcc, 13, v7
    v_lshl_add_u32 v69, v49, 3, v69
    ds_write_b64 v69, v[102:103]
    v_cmpx_lt_u32 vcc, 14, v7
    s_cbranch_execz L_pdone
    v_lshl_add_u32 v70, v50, 3, v70
    ds_write_b64 v70, v[104:105]
    v_cmpx_lt_u32 vcc, 15, v7
    v_lshl_add_u32 v71, v51, 3, v71
    ds_write_b64 v71, v[106:107]
    v_cmpx_lt_u32 vcc, 16, v7
    s_cbranch_execz L_pdone
    v_lshl_add_u32 v72, v52, 3, v72
    ds_write_b64 v72, v[108:109]
    v_cmpx_lt_u32 vcc, 17, v7
    v_lshl_add_u32 v73, v53, 3, v73
    ds_write_b64 v73, v[110:111]
    v_cmpx_lt_u32 vcc, 18, v7
    s_cbranch_execz L_pdone
    v_lshl_add_u32 v74, v54, 3, v74
    ds_write_b64 v74, v[112:113]
    v_cmpx_lt_u32 vcc, 19, v7
    v_lshl_add_u32 v75, v55, 3, v75
    ds_write_b64 v75, v[114:115]
L_pdone:
    s_mov_b64 exec, -1
    s_cmp_gt_u32 s30, 0
    s_cselect_b32 s10, s41, 0
    s_cselect_b32 s58, s42, 0
    s_waitcnt vmcnt(1) lgkmcnt(0)
    s_barrier
    s_cmp_ge_u32 s28, 4
    s_cbranch_scc1 L_fillb
    ds_read_b32 v228, v249 offset:0
    ds_read_b32 v230, v249 offset:8
    ds_read_b32 v232, v249 offset:16
    ds_read_b32 v234, v249 offset:24
    ds_read_b32 v236, v250 offset:4
    v_mul_u32_u24 v226, 640, v1
    v_add_u32 v226, 115328, v226
    v_add_u32 v227, s28, v223
    v_lshlrev_b32 v227, 2, v227
    v_add_u32 v227, 111616, v227
    s_mov_b32 s46, s28
    s_cmp_eq_u32 s46, 0
    s_cselect_b32 s48, 0x80000000, 0
    v_or_b32 v254, s48, v226
    s_waitcnt lgkmcnt(0)
    s_add_u32 m0, s38, 0
    s_nop 0
    buffer_load_dwordx4 v[228:229], s[8:11], 0 idxen offen offset:0 lds
    buffer_load_dwordx4 v[230:231], s[8:11], 0 idxen offen offset:1024 lds
    buffer_load_dwordx4 v[232:233], s[8:11], 0 idxen offen offset:2048 lds
    buffer_load_dwordx4 v[234:235], s[8:11], 0 idxen offen offset:3072 lds
    s_add_u32 m0, s38, 4096
    s_nop 0
    buffer_load_dwordx4 v[236:237], s[56:59], 0 idxen offen lds
    ds_read_b32 v228, v249 offset:128
    ds_read_b32 v230, v249 offset:136
    ds_read_b32 v232, v249 offset:144
    ds_read_b32 v234, v249 offset:152
    ds_read_b32 v236, v250 offset:132
    s_cmp_lg_u32 s51, 0
    s_cbranch_scc1 L_anow
    s_mov_b32 s51, 1
    ds_read_b128 v[212:215], v10 offset:8192
    ds_read_b128 v[148:151], v10 offset:6144
    ds_read_b128 v[152:155], v10 offset:16384
    ds_read_b128 v[156:159], v10 offset:26624
    ds_read_b128 v[160:163], v10 offset:36864
    ds_read_b128 v[216:219], v10 offset:18432
    ds_read_b128 v[164:167], v255 offset:6144
    ds_read_b128 v[168:171], v255 offset:16384
    ds_read_b128 v[172:175], v255 offset:26624
    ds_read_b128 v[176:179], v255 offset:36864
    ds_read_b128 v[180:183], v10 offset:7168
    ds_read_b128 v[184:187], v10 offset:17408
    ds_read_b128 v[188:191], v10 offset:27648
    ds_read_b128 v[192:195], v10 offset:37888
    ds_read_b128 v[196:199], v255 offset:7168
    ds_read_b128 v[200:203], v255 offset:17408
    ds_read_b128 v[204:207], v255 offset:27648
    ds_read_b128 v[208:211], v255 offset:37888
    v_add_u32 v244, s38, v244
    v_add_u32 v245, s38, v245
    v_add_u32 v246, s38, v246
    v_add_u32 v247, s38, v247
    v_add_u32 v248, s38, v143
L_anow:
    v_cmpx_lt_u32 vcc, s46, v222
    ds_write_b32 v227, v254 offset:0
    s_add_u32 s46, s46, 4
    v_cmpx_lt_u32 vcc, s46, v222
    ds_write_b32 v227, v226 offset:16
    s_add_u32 s46, s46, 4
    v_cmpx_lt_u32 vcc, s46, v222
    ds_write_b32 v227, v226 offset:32
    s_add_u32 s46, s46, 4
    v_cmpx_lt_u32 vcc, s46, v222
    ds_write_b32 v227, v226 offset:48
    s_add_u32 s46, s46, 4
    v_cmpx_lt_u32 vcc, s46, v222
    ds_write_b32 v227, v226 offset:64
    s_add_u32 s46, s46, 4
    v_cmpx_lt_u32 vcc, s46, v222
    ds_write_b32 v227, v226 offset:80
    s_add_u32 s46, s46, 4
    v_add_u32 v227, 96, v227
L_qloop:
    v_cmpx_lt_u32 vcc, s46, v222
    s_cbranch_execz L_qdone
    ds_write_b32 v227, v226
    v_add_u32 v227, 16, v227
    s_add_u32 s46, s46, 4
    s_branch L_qloop
L_qdone:
    s_mov_b64 exec, -1
    s_cmp_eq_u32 s28, 3
    s_cbranch_scc0 L_qtdone
    s_lshl_b32 s46, s45, 3
    s_sub_u32 s46, s46, s3
    s_lshl_b32 s48, s3, 2
    s_add_u32 s48, s48, 111616
    v_mov_b32 v8, 147328
    v_cmpx_gt_u32 vcc, s46, v1
    v_lshl_add_u32 v2, v1, 2, s48
    ds_write_b32 v2, v8
    s_mov_b64 exec, -1
L_qtdone:
    s_waitcnt lgkmcnt(0)
    s_barrier
    ds_read_b32 v226, v251
    s_cmp_eq_u32 s30, 0
    s_cbranch_scc1 L_rend
    s_cmp_gt_u32 s30, 1
    s_cselect_b32 s10, s41, 0
    s_cselect_b32 s58, s42, 0
    s_add_u32 m0, s38, 5120
    s_nop 0
    buffer_load_dwordx4 v[228:229], s[8:11], 0 idxen offen offset:0 lds
    buffer_load_dwordx4 v[230:231], s[8:11], 0 idxen offen offset:1024 lds
    buffer_load_dwordx4 v[232:233], s[8:11], 0 idxen offen offset:2048 lds
    buffer_load_dwordx4 v[234:235], s[8:11], 0 idxen offen offset:3072 lds
    s_add_u32 m0, s38, 9216
    s_nop 0
    buffer_load_dwordx4 v[236:237], s[56:59], 0 idxen offen lds
    s_waitcnt lgkmcnt(0)
    v_and_or_b32 v2, v226, s43, v238
    v_cmp_gt_i32 s[32:33], 0, v226
    ds_read_b64_tr_b16 v[132:133], v2 offset:512
    ds_read_b64_tr_b16 v[136:137], v2 offset:576
    v_mov_b32_dpp v8, v226 row_newbcast:0 row_mask:0xf bank_mask:0xf
    v_mov_b32 v220, 0
    v_mov_b32 v221, 0
    v_or_b32 v8, 0x80000000, v8
    s_or_b32 s34, s32, s33
    v_add_u32 v222, v8, v239
    v_add_u32 v223, v8, v239
    s_waitcnt vmcnt(5)
    ds_read_b128 v[128:131], v248
    ds_read_b128 v[112:115], v244
    ds_read_b128 v[116:119], v245
    ds_read_b128 v[120:123], v246
    ds_read_b128 v[124:127], v247
    s_waitcnt lgkmcnt(4)
    v_mfma_f32_32x32x16_bf16 v[16:31], v[128:131], v[212:215], 0
    s_waitcnt lgkmcnt(3)
    v_mfma_f32_32x32x16_bf16 v[16:31], v[112:115], v[148:151], v[16:31]
    s_waitcnt lgkmcnt(2)
    v_mfma_f32_32x32x16_bf16 v[16:31], v[116:119], v[152:155], v[16:31]
    s_waitcnt lgkmcnt(1)
    v_mfma_f32_32x32x16_bf16 v[16:31], v[120:123], v[156:159], v[16:31]
    s_waitcnt lgkmcnt(0)
    v_mfma_f32_32x32x16_bf16 v[16:31], v[124:127], v[160:163], v[16:31]
    s_branch L_filld
L_fillb:
    s_cmp_lg_u32 s51, 0
    s_cbranch_scc1 L_bnow
    s_and_b32 s46, s28, 1
    s_bfe_u32 s49, s28, 0x10001
    s_lshl_b32 s48, s46, 12
    v_add_u32 v2, s48, v243
    ds_read_b128 v[116:119], v2
    v_xor_b32 v8, 32, v2
    ds_read_b128 v[120:123], v8
    v_xor_b32 v8, 64, v2
    ds_read_b128 v[124:127], v8
    v_xor_b32 v8, 96, v2
    ds_read_b128 v[128:131], v8
    s_mul_i32 s48, s49, 40960
    v_add_u32 v132, s48, v10
    s_mul_i32 s48, s49, -39936
    v_add_u32 v133, s48, v255
    ds_read_b128 v[164:167], v132 offset:28672
    ds_read_b128 v[168:171], v132 offset:38912
    ds_read_b128 v[172:175], v133 offset:8192
    ds_read_b128 v[176:179], v133 offset:18432
    s_mul_i32 s48, s46, 20480
    v_mul_u32_u24 v2, 2560, v14
    s_lshl_b32 s46, s49, 8
    s_add_u32 s46, s46, s48
    s_add_u32 s46, s46, 115328
    v_lshl_add_u32 v136, v15, 3, v2
    v_add_u32 v136, s46, v136
    s_lshl_b32 s46, s49, 6
    s_add_u32 s46, s46, s48
    s_add_u32 s46, s46, 115840
    v_lshl_add_u32 v137, v15, 1, v2
    v_add_u32 v137, s46, v137
    ds_read_b32 v228, v249 offset:0
    ds_read_b32 v230, v249 offset:8
    ds_read_b32 v232, v249 offset:16
    ds_read_b32 v234, v249 offset:24
    ds_read_b32 v236, v250 offset:4
    s_waitcnt lgkmcnt(8)
    v_mfma_f32_32x32x16_bf16 v[180:195], v[116:119], v[164:167], 0
    s_waitcnt lgkmcnt(7)
    v_mfma_f32_32x32x16_bf16 v[180:195], v[120:123], v[168:171], v[180:195]
    s_waitcnt lgkmcnt(6)
    v_mfma_f32_32x32x16_bf16 v[180:195], v[124:127], v[172:175], v[180:195]
    s_waitcnt lgkmcnt(5)
    v_mfma_f32_32x32x16_bf16 v[180:195], v[128:131], v[176:179], v[180:195]
    ds_read_b128 v[148:151], v10 offset:6144
    ds_read_b128 v[152:155], v10 offset:16384
    ds_read_b128 v[156:159], v10 offset:26624
    ds_read_b128 v[160:163], v10 offset:36864
    ds_read_b128 v[164:167], v255 offset:6144
    ds_read_b128 v[168:171], v255 offset:16384
    ds_read_b128 v[172:175], v255 offset:26624
    ds_read_b128 v[176:179], v255 offset:36864
    ds_read_b128 v[212:215], v10 offset:8192
    ds_read_b128 v[216:219], v10 offset:18432
    ds_read_b128 v[32:35], v132 offset:29696
    ds_read_b128 v[36:39], v132 offset:39936
    ds_read_b128 v[40:43], v133 offset:9216
    ds_read_b128 v[44:47], v133 offset:19456
    s_mov_b32 s48, 0xbfb8aa3b
    s_and_b32 s46, s28, 1
    v_mul_f32 v180, s48, v180
    v_mul_f32 v181, s48, v181
    v_mul_f32 v182, s48, v182
    v_mul_f32 v183, s48, v183
    v_cvt_pk_bf16_f32 v180, v180, v181
    ds_write_b16 v137, v180 offset:0
    ds_write_b16_d16_hi v137, v180 offset:640
    v_cvt_pk_bf16_f32 v182, v182, v183
    ds_write_b16 v137, v182 offset:1280
    ds_write_b16_d16_hi v137, v182 offset:1920
    v_mul_f32 v184, s48, v184
    v_mul_f32 v185, s48, v185
    v_mul_f32 v186, s48, v186
    v_mul_f32 v187, s48, v187
    v_cvt_pk_bf16_f32 v184, v184, v185
    ds_write_b16 v137, v184 offset:5120
    ds_write_b16_d16_hi v137, v184 offset:5760
    v_cvt_pk_bf16_f32 v186, v186, v187
    ds_write_b16 v137, v186 offset:6400
    ds_write_b16_d16_hi v137, v186 offset:7040
    s_cmp_eq_u32 s46, 0
    s_cselect_b32 exec_hi, -1, 0
    v_mul_f32 v188, s48, v188
    v_mul_f32 v189, s48, v189
    v_mul_f32 v190, s48, v190
    v_mul_f32 v191, s48, v191
    v_cvt_pk_bf16_f32 v188, v188, v189
    ds_write_b16 v137, v188 offset:10240
    ds_write_b16_d16_hi v137, v188 offset:10880
    v_cvt_pk_bf16_f32 v190, v190, v191
    ds_write_b16 v137, v190 offset:11520
    ds_write_b16_d16_hi v137, v190 offset:12160
    s_cbranch_scc0 L_xdone
    v_mul_f32 v192, s48, v192
    v_mul_f32 v193, s48, v193
    v_mul_f32 v194, s48, v194
    v_mul_f32 v195, s48, v195
    v_cvt_pk_bf16_f32 v192, v192, v193
    ds_write_b16 v137, v192 offset:15360
    ds_write_b16_d16_hi v137, v192 offset:16000
    v_cvt_pk_bf16_f32 v194, v194, v195
    ds_write_b16 v137, v194 offset:16640
    ds_write_b16_d16_hi v137, v194 offset:17280
L_xdone:
    s_mov_b64 exec, -1
    ds_read_b128 v[180:183], v10 offset:7168
    ds_read_b128 v[184:187], v10 offset:17408
    ds_read_b128 v[188:191], v10 offset:27648
    ds_read_b128 v[192:195], v10 offset:37888
    ds_read_b128 v[196:199], v255 offset:7168
    ds_read_b128 v[200:203], v255 offset:17408
    ds_read_b128 v[204:207], v255 offset:27648
    ds_read_b128 v[208:211], v255 offset:37888
    v_add_u32 v244, s38, v244
    v_add_u32 v245, s38, v245
    v_add_u32 v246, s38, v246
    v_add_u32 v247, s38, v247
    v_add_u32 v248, s38, v143
    s_branch L_bbar
L_bnow:
    ds_read_b32 v228, v249 offset:0
    ds_read_b32 v230, v249 offset:8
    ds_read_b32 v232, v249 offset:16
    ds_read_b32 v234, v249 offset:24
    ds_read_b32 v236, v250 offset:4
L_bbar:
    s_waitcnt lgkmcnt(0)
    s_barrier
    ds_read_b32 v226, v251
    s_add_u32 m0, s38, 0
    s_nop 0
    buffer_load_dwordx4 v[228:229], s[8:11], 0 idxen offen offset:0 lds
    buffer_load_dwordx4 v[230:231], s[8:11], 0 idxen offen offset:1024 lds
    buffer_load_dwordx4 v[232:233], s[8:11], 0 idxen offen offset:2048 lds
    buffer_load_dwordx4 v[234:235], s[8:11], 0 idxen offen offset:3072 lds
    s_add_u32 m0, s38, 4096
    s_nop 0
    buffer_load_dwordx4 v[236:237], s[56:59], 0 idxen offen lds
    ds_read_b32 v228, v249 offset:128
    ds_read_b32 v230, v249 offset:136
    ds_read_b32 v232, v249 offset:144
    ds_read_b32 v234, v249 offset:152
    ds_read_b32 v236, v250 offset:132
    s_cmp_lg_u32 s51, 0
    s_cbranch_scc1 L_noxu
    s_mov_b32 s51, 1
    v_mfma_f32_32x32x16_bf16 v[48:63], v[116:119], v[32:35], 0
    v_mfma_f32_32x32x16_bf16 v[48:63], v[120:123], v[36:39], v[48:63]
    v_mfma_f32_32x32x16_bf16 v[48:63], v[124:127], v[40:43], v[48:63]
    v_mfma_f32_32x32x16_bf16 v[48:63], v[128:131], v[44:47], v[48:63]
    s_and_b32 s46, s28, 1
    s_nop 7
    s_nop 3
    v_cvt_f64_f32 v[96:97], v48
    ds_add_f64 v136, v[96:97] offset:0
    v_cvt_f64_f32 v[98:99], v49
    ds_add_f64 v136, v[98:99] offset:640
    v_cvt_f64_f32 v[100:101], v50
    ds_add_f64 v136, v[100:101] offset:1280
    v_cvt_f64_f32 v[102:103], v51
    ds_add_f64 v136, v[102:103] offset:1920
    v_cvt_f64_f32 v[96:97], v52
    ds_add_f64 v136, v[96:97] offset:5120
    v_cvt_f64_f32 v[98:99], v53
    ds_add_f64 v136, v[98:99] offset:5760
    v_cvt_f64_f32 v[100:101], v54
    ds_add_f64 v136, v[100:101] offset:6400
    v_cvt_f64_f32 v[102:103], v55
    ds_add_f64 v136, v[102:103] offset:7040
    s_cmp_eq_u32 s46, 0
    s_cselect_b32 exec_hi, -1, 0
    v_cvt_f64_f32 v[96:97], v56
    ds_add_f64 v136, v[96:97] offset:10240
    v_cvt_f64_f32 v[98:99], v57
    ds_add_f64 v136, v[98:99] offset:10880
    v_cvt_f64_f32 v[100:101], v58
    ds_add_f64 v136, v[100:101] offset:11520
    v_cvt_f64_f32 v[102:103], v59
    ds_add_f64 v136, v[102:103] offset:12160
    s_cbranch_scc0 L_xudone
    v_cvt_f64_f32 v[96:97], v60
    ds_add_f64 v136, v[96:97] offset:15360
    v_cvt_f64_f32 v[98:99], v61
    ds_add_f64 v136, v[98:99] offset:16000
    v_cvt_f64_f32 v[100:101], v62
    ds_add_f64 v136, v[100:101] offset:16640
    v_cvt_f64_f32 v[102:103], v63
    ds_add_f64 v136, v[102:103] offset:17280
L_xudone:
    s_mov_b64 exec, -1
L_noxu:
    s_cmp_eq_u32 s30, 0
    s_cbranch_scc1 L_rend
    s_cmp_gt_u32 s30, 1
    s_cselect_b32 s10, s41, 0
    s_cselect_b32 s58, s42, 0
    s_waitcnt lgkmcnt(0)
    s_add_u32 m0, s38, 5120
    s_nop 0
    buffer_load_dwordx4 v[228:229], s[8:11], 0 idxen offen offset:0 lds
    buffer_load_dwordx4 v[230:231], s[8:11], 0 idxen offen offset:1024 lds
    buffer_load_dwordx4 v[232:233], s[8:11], 0 idxen offen offset:2048 lds
    buffer_load_dwordx4 v[234:235], s[8:11], 0 idxen offen offset:3072 lds
    s_add_u32 m0, s38, 9216
    s_nop 0
    buffer_load_dwordx4 v[236:237], s[56:59], 0 idxen offen lds
    v_and_or_b32 v2, v226, s43, v238
    v_cmp_gt_i32 s[32:33], 0, v226
    ds_read_b64_tr_b16 v[132:133], v2 offset:512
    ds_read_b64_tr_b16 v[136:137], v2 offset:576
    v_mov_b32_dpp v8, v226 row_newbcast:0 row_mask:0xf bank_mask:0xf
    v_mov_b32 v220, 0
    v_mov_b32 v221, 0
    v_or_b32 v8, 0x80000000, v8
    s_or_b32 s34, s32, s33
    v_add_u32 v222, v8, v239
    v_add_u32 v223, v8, v239
    s_waitcnt vmcnt(5)
    ds_read_b128 v[128:131], v248
    ds_read_b128 v[112:115], v244
    ds_read_b128 v[116:119], v245
    ds_read_b128 v[120:123], v246
    ds_read_b128 v[124:127], v247
    s_waitcnt lgkmcnt(4)
    v_mfma_f32_32x32x16_bf16 v[16:31], v[128:131], v[212:215], 0
    s_waitcnt lgkmcnt(3)
    v_mfma_f32_32x32x16_bf16 v[16:31], v[112:115], v[148:151], v[16:31]
    s_waitcnt lgkmcnt(2)
    v_mfma_f32_32x32x16_bf16 v[16:31], v[116:119], v[152:155], v[16:31]
    s_waitcnt lgkmcnt(1)
    v_mfma_f32_32x32x16_bf16 v[16:31], v[120:123], v[156:159], v[16:31]
    s_waitcnt lgkmcnt(0)
    v_mfma_f32_32x32x16_bf16 v[16:31], v[124:127], v[160:163], v[16:31]
L_filld:
    v_mfma_f32_32x32x8bf16_1k v[16:31], v[140:141], v[132:133], v[16:31]
    s_nop 7
    s_nop 3
    ds_read_b32 v228, v249 offset:256
    ds_read_b32 v230, v249 offset:264
    ds_read_b32 v232, v249 offset:272
    ds_read_b32 v234, v249 offset:280
    ds_read_b32 v236, v250 offset:260
    s_cmp_gt_u32 s30, 2
    s_cselect_b32 s10, s41, 0
    s_cselect_b32 s58, s42, 0
    v_mfma_f32_32x32x8bf16_1k v[32:47], v[140:141], v[136:137], 0
    v_exp_f32 v16, v16
    v_exp_f32 v17, v17
    v_mfma_f32_32x32x16_bf16 v[80:95], v[112:115], v[180:183], 0
    v_exp_f32 v18, v18
    v_exp_f32 v19, v19
    v_mfma_f32_32x32x16_bf16 v[32:47], v[128:131], v[216:219], v[32:47]
    v_exp_f32 v20, v20
    v_exp_f32 v21, v21
    v_mfma_f32_32x32x16_bf16 v[80:95], v[116:119], v[184:187], v[80:95]
    v_exp_f32 v22, v22
    v_exp_f32 v23, v23
    v_mfma_f32_32x32x16_bf16 v[32:47], v[112:115], v[164:167], v[32:47]
    s_waitcnt lgkmcnt(0)
    s_add_u32 m0, s38, 0
    s_nop 0
    buffer_load_dwordx4 v[228:229], s[8:11], 0 idxen offen offset:0 lds
    v_exp_f32 v24, v24
    v_exp_f32 v25, v25
    v_mfma_f32_32x32x16_bf16 v[80:95], v[120:123], v[188:191], v[80:95]
    buffer_load_dwordx4 v[230:231], s[8:11], 0 idxen offen offset:1024 lds
    v_exp_f32 v26, v26
    v_exp_f32 v27, v27
    v_mfma_f32_32x32x16_bf16 v[32:47], v[116:119], v[168:171], v[32:47]
    v_exp_f32 v28, v28
    v_exp_f32 v29, v29
    v_mfma_f32_32x32x16_bf16 v[80:95], v[124:127], v[192:195], v[80:95]
    v_exp_f32 v30, v30
    v_exp_f32 v31, v31
    v_mfma_f32_32x32x16_bf16 v[32:47], v[120:123], v[172:175], v[32:47]
    s_nop 0
    v_mfma_f32_32x32x8bf16_1k v[48:63], v[144:145], v[146:147], v[16:31]
    v_mfma_f32_32x32x16_bf16 v[32:47], v[124:127], v[176:179], v[32:47]
    ds_read_b32 v227, v251 offset:16
    s_nop 7
    s_branch L_s1_u0
.p2align 6
L_u0:
    ds_read_b32 v228, v249 offset:256
    ds_read_b32 v230, v249 offset:264
    ds_read_b32 v232, v249 offset:272
    ds_read_b32 v234, v249 offset:280
    ds_read_b32 v236, v250 offset:260
    v_mfma_f32_32x32x8bf16_1k v[32:47], v[140:141], v[136:137], 0
    s_setprio 0
    v_exp_f32 v16, v16
    v_exp_f32 v17, v17
    v_exp_f32 v18, v18
    v_mfma_f32_32x32x16_bf16 v[80:95], v[112:115], v[180:183], 0
    v_exp_f32 v19, v19
    v_rcp_f32 v64, v64
    v_rcp_f32 v65, v65
    v_mfma_f32_32x32x16_bf16 v[32:47], v[128:131], v[216:219], v[32:47]
    v_rcp_f32 v66, v66
    v_rcp_f32 v67, v67
    s_waitcnt lgkmcnt(0)
    s_bitcmp1_b32 s35, 0
    s_cbranch_scc1 L_fl_a0_0
L_bk_a0_0:
    v_exp_f32 v20, v20
    v_fmac_f32 v221, v64, v96
    v_mfma_f32_32x32x16_bf16 v[80:95], v[116:119], v[184:187], v[80:95]
    v_exp_f32 v21, v21
    v_fmac_f32 v221, v65, v97
    v_exp_f32 v22, v22
    v_fmac_f32 v221, v66, v98
    v_mfma_f32_32x32x16_bf16 v[32:47], v[112:115], v[164:167], v[32:47]
    v_exp_f32 v23, v23
    v_fmac_f32 v221, v67, v99
    v_rcp_f32 v68, v68
    v_rcp_f32 v69, v69
    v_mfma_f32_32x32x16_bf16 v[80:95], v[120:123], v[188:191], v[80:95]
    v_rcp_f32 v70, v70
    s_add_u32 m0, s38, 0
    v_rcp_f32 v71, v71
    buffer_load_dwordx4 v[228:229], s[8:11], 0 idxen offen offset:0 lds
    s_bitcmp1_b32 s35, 4
    s_cbranch_scc1 L_fl_a0_1
L_bk_a0_1:
    v_exp_f32 v24, v24
    v_fmac_f32 v221, v68, v100
    v_mfma_f32_32x32x16_bf16 v[32:47], v[116:119], v[168:171], v[32:47]
    v_exp_f32 v25, v25
    v_fmac_f32 v221, v69, v101
    v_exp_f32 v26, v26
    v_fmac_f32 v221, v70, v102
    v_mfma_f32_32x32x16_bf16 v[80:95], v[124:127], v[192:195], v[80:95]
    v_exp_f32 v27, v27
    v_fmac_f32 v221, v71, v103
    v_rcp_f32 v72, v72
    v_mfma_f32_32x32x16_bf16 v[32:47], v[120:123], v[172:175], v[32:47]
    v_rcp_f32 v73, v73
    v_rcp_f32 v74, v74
    v_rcp_f32 v75, v75
    s_bitcmp1_b32 s35, 8
    s_cbranch_scc1 L_fl_a0_2
L_bk_a0_2:
    v_exp_f32 v28, v28
    v_fmac_f32 v221, v72, v104
    v_mfma_f32_32x32x16_bf16 v[32:47], v[124:127], v[176:179], v[32:47]
    v_exp_f32 v29, v29
    v_fmac_f32 v221, v73, v105
    v_exp_f32 v30, v30
    v_fmac_f32 v221, v74, v106
    buffer_load_dwordx4 v[230:231], s[8:11], 0 idxen offen offset:1024 lds
    v_exp_f32 v31, v31
    v_fmac_f32 v221, v75, v107
    v_rcp_f32 v76, v76
    v_rcp_f32 v77, v77
    v_mfma_f32_32x32x8bf16_1k v[48:63], v[144:145], v[146:147], v[16:31]
    v_rcp_f32 v78, v78
    v_rcp_f32 v79, v79
    s_bitcmp1_b32 s35, 12
    s_cbranch_scc1 L_fl_a0_3
L_bk_a0_3:
    v_fmac_f32 v221, v76, v108
    v_fmac_f32 v221, v77, v109
    v_fmac_f32 v221, v78, v110
    v_fmac_f32 v221, v79, v111
    ds_read_b32 v227, v251 offset:16
L_s1_u0:
    s_waitcnt vmcnt(2)
    ds_read_b128 v[128:131], v248 offset:5120
    v_mfma_f32_32x32x16_bf16 v[96:111], v[112:115], v[196:199], 0
    ds_read_b128 v[112:115], v244 offset:5120
    s_setprio 1
    v_exp_f32 v32, v32
    v_exp_f32 v33, v33
    s_waitcnt lgkmcnt(2)
    v_and_or_b32 v2, v227, s43, v238
    v_cmp_gt_i32 s[36:37], 0, v227
    ds_read_b64_tr_b16 v[132:133], v2 offset:512
    ds_read_b64_tr_b16 v[136:137], v2 offset:576
    v_exp_f32 v34, v34
    v_mfma_f32_32x32x16_bf16 v[96:111], v[116:119], v[200:203], v[96:111]
    ds_read_b128 v[116:119], v245 offset:5120
    v_exp_f32 v35, v35
    v_rcp_f32 v48, v48
    v_rcp_f32 v49, v49
    v_mfma_f32_32x32x16_bf16 v[96:111], v[120:123], v[204:207], v[96:111]
    ds_read_b128 v[120:123], v246 offset:5120
    s_or_b32 s35, s36, s37
    v_rcp_f32 v50, v50
    v_rcp_f32 v51, v51
    buffer_load_dwordx4 v[232:233], s[8:11], 0 idxen offen offset:2048 lds
    s_bitcmp1_b32 s34, 0
    s_cbranch_scc1 L_fl_b0_0
L_bk_b0_0:
    v_exp_f32 v36, v36
    v_fmac_f32 v220, v48, v80
    v_mfma_f32_32x32x16_bf16 v[96:111], v[124:127], v[208:211], v[96:111]
    ds_read_b128 v[124:127], v247 offset:5120
    v_exp_f32 v37, v37
    v_fmac_f32 v220, v49, v81
    v_exp_f32 v38, v38
    v_fmac_f32 v220, v50, v82
    s_waitcnt lgkmcnt(4)
    v_mfma_f32_32x32x8bf16_1k v[16:31], v[140:141], v[132:133], 0
    v_exp_f32 v39, v39
    v_fmac_f32 v220, v51, v83
    v_rcp_f32 v52, v52
    v_rcp_f32 v53, v53
    v_mfma_f32_32x32x16_bf16 v[16:31], v[128:131], v[212:215], v[16:31]
    v_rcp_f32 v54, v54
    v_rcp_f32 v55, v55
    s_bitcmp1_b32 s34, 4
    s_cbranch_scc1 L_fl_b0_1
L_bk_b0_1:
    v_exp_f32 v40, v40
    v_fmac_f32 v220, v52, v84
    v_mfma_f32_32x32x16_bf16 v[16:31], v[112:115], v[148:151], v[16:31]
    v_exp_f32 v41, v41
    v_fmac_f32 v220, v53, v85
    v_exp_f32 v42, v42
    v_fmac_f32 v220, v54, v86
    s_waitcnt lgkmcnt(0)
    v_mfma_f32_32x32x16_bf16 v[16:31], v[116:119], v[152:155], v[16:31]
    buffer_load_dwordx4 v[234:235], s[8:11], 0 idxen offen offset:3072 lds
    v_exp_f32 v43, v43
    v_fmac_f32 v220, v55, v87
    v_rcp_f32 v56, v56
    v_mfma_f32_32x32x16_bf16 v[16:31], v[120:123], v[156:159], v[16:31]
    v_rcp_f32 v57, v57
    v_rcp_f32 v58, v58
    v_rcp_f32 v59, v59
    s_bitcmp1_b32 s34, 8
    s_cbranch_scc1 L_fl_b0_2
L_bk_b0_2:
    v_exp_f32 v44, v44
    v_fmac_f32 v220, v56, v88
    v_mfma_f32_32x32x16_bf16 v[16:31], v[124:127], v[160:163], v[16:31]
    v_exp_f32 v45, v45
    v_fmac_f32 v220, v57, v89
    v_exp_f32 v46, v46
    v_fmac_f32 v220, v58, v90
    v_exp_f32 v47, v47
    v_fmac_f32 v220, v59, v91
    v_rcp_f32 v60, v60
    v_rcp_f32 v61, v61
    v_mfma_f32_32x32x8bf16_1k v[64:79], v[144:145], v[146:147], v[32:47]
    v_rcp_f32 v62, v62
    s_add_u32 m0, s38, 4096
    v_rcp_f32 v63, v63
    buffer_load_dwordx4 v[236:237], s[56:59], 0 idxen offen lds
    s_bitcmp1_b32 s34, 12
    s_cbranch_scc1 L_fl_b0_3
L_bk_b0_3:
    v_fmac_f32 v220, v60, v92
    v_fmac_f32 v220, v61, v93
    v_fmac_f32 v220, v62, v94
    v_fmac_f32 v220, v63, v95
    s_sub_u32 s30, s30, 1
    s_cmp_gt_u32 s30, 2
    s_cbranch_scc0 L_tail0
L_u1:
    ds_read_b32 v228, v249 offset:384
    ds_read_b32 v230, v249 offset:392
    ds_read_b32 v232, v249 offset:400
    ds_read_b32 v234, v249 offset:408
    ds_read_b32 v236, v250 offset:388
    v_mfma_f32_32x32x8bf16_1k v[32:47], v[140:141], v[136:137], 0
    s_setprio 0
    v_exp_f32 v16, v16
    v_exp_f32 v17, v17
    v_exp_f32 v18, v18
    v_mfma_f32_32x32x16_bf16 v[80:95], v[112:115], v[180:183], 0
    v_exp_f32 v19, v19
    v_rcp_f32 v64, v64
    v_rcp_f32 v65, v65
    v_mfma_f32_32x32x16_bf16 v[32:47], v[128:131], v[216:219], v[32:47]
    v_rcp_f32 v66, v66
    v_rcp_f32 v67, v67
    s_waitcnt lgkmcnt(0)
    s_bitcmp1_b32 s34, 0
    s_cbranch_scc1 L_fl_a1_0
L_bk_a1_0:
    v_exp_f32 v20, v20
    v_fmac_f32 v221, v64, v96
    v_mfma_f32_32x32x16_bf16 v[80:95], v[116:119], v[184:187], v[80:95]
    v_exp_f32 v21, v21
    v_fmac_f32 v221, v65, v97
    v_exp_f32 v22, v22
    v_fmac_f32 v221, v66, v98
    v_mfma_f32_32x32x16_bf16 v[32:47], v[112:115], v[164:167], v[32:47]
    v_exp_f32 v23, v23
    v_fmac_f32 v221, v67, v99
    v_rcp_f32 v68, v68
    v_rcp_f32 v69, v69
    v_mfma_f32_32x32x16_bf16 v[80:95], v[120:123], v[188:191], v[80:95]
    v_rcp_f32 v70, v70
    s_add_u32 m0, s38, 5120
    v_rcp_f32 v71, v71
    buffer_load_dwordx4 v[228:229], s[8:11], 0 idxen offen offset:0 lds
    s_bitcmp1_b32 s34, 4
    s_cbranch_scc1 L_fl_a1_1
L_bk_a1_1:
    v_exp_f32 v24, v24
    v_fmac_f32 v221, v68, v100
    v_mfma_f32_32x32x16_bf16 v[32:47], v[116:119], v[168:171], v[32:47]
    v_exp_f32 v25, v25
    v_fmac_f32 v221, v69, v101
    v_exp_f32 v26, v26
    v_fmac_f32 v221, v70, v102
    v_mfma_f32_32x32x16_bf16 v[80:95], v[124:127], v[192:195], v[80:95]
    v_exp_f32 v27, v27
    v_fmac_f32 v221, v71, v103
    v_rcp_f32 v72, v72
    v_mfma_f32_32x32x16_bf16 v[32:47], v[120:123], v[172:175], v[32:47]
    v_rcp_f32 v73, v73
    v_rcp_f32 v74, v74
    v_rcp_f32 v75, v75
    s_bitcmp1_b32 s34, 8
    s_cbranch_scc1 L_fl_a1_2
L_bk_a1_2:
    v_exp_f32 v28, v28
    v_fmac_f32 v221, v72, v104
    v_mfma_f32_32x32x16_bf16 v[32:47], v[124:127], v[176:179], v[32:47]
    v_exp_f32 v29, v29
    v_fmac_f32 v221, v73, v105
    v_exp_f32 v30, v30
    v_fmac_f32 v221, v74, v106
    buffer_load_dwordx4 v[230:231], s[8:11], 0 idxen offen offset:1024 lds
    v_exp_f32 v31, v31
    v_fmac_f32 v221, v75, v107
    v_rcp_f32 v76, v76
    v_rcp_f32 v77, v77
    v_mfma_f32_32x32x8bf16_1k v[48:63], v[144:145], v[146:147], v[16:31]
    v_rcp_f32 v78, v78
    v_rcp_f32 v79, v79
    s_bitcmp1_b32 s34, 12
    s_cbranch_scc1 L_fl_a1_3
L_bk_a1_3:
    v_fmac_f32 v221, v76, v108
    v_fmac_f32 v221, v77, v109
    v_fmac_f32 v221, v78, v110
    v_fmac_f32 v221, v79, v111
    ds_read_b32 v226, v251 offset:32
    s_waitcnt vmcnt(2)
    ds_read_b128 v[128:131], v248 offset:0
    v_mfma_f32_32x32x16_bf16 v[96:111], v[112:115], v[196:199], 0
    ds_read_b128 v[112:115], v244 offset:0
    s_setprio 1
    v_exp_f32 v32, v32
    v_exp_f32 v33, v33
    s_waitcnt lgkmcnt(2)
    v_and_or_b32 v2, v226, s43, v238
    v_cmp_gt_i32 s[32:33], 0, v226
    ds_read_b64_tr_b16 v[132:133], v2 offset:512
    ds_read_b64_tr_b16 v[136:137], v2 offset:576
    v_exp_f32 v34, v34
    v_mfma_f32_32x32x16_bf16 v[96:111], v[116:119], v[200:203], v[96:111]
    ds_read_b128 v[116:119], v245 offset:0
    v_exp_f32 v35, v35
    v_rcp_f32 v48, v48
    v_rcp_f32 v49, v49
    v_mfma_f32_32x32x16_bf16 v[96:111], v[120:123], v[204:207], v[96:111]
    ds_read_b128 v[120:123], v246 offset:0
    s_or_b32 s34, s32, s33
    v_rcp_f32 v50, v50
    v_rcp_f32 v51, v51
    buffer_load_dwordx4 v[232:233], s[8:11], 0 idxen offen offset:2048 lds
    s_bitcmp1_b32 s35, 0
    s_cbranch_scc1 L_fl_b1_0
L_bk_b1_0:
    v_exp_f32 v36, v36
    v_fmac_f32 v220, v48, v80
    v_mfma_f32_32x32x16_bf16 v[96:111], v[124:127], v[208:211], v[96:111]
    ds_read_b128 v[124:127], v247 offset:0
    v_exp_f32 v37, v37
    v_fmac_f32 v220, v49, v81
    v_exp_f32 v38, v38
    v_fmac_f32 v220, v50, v82
    s_waitcnt lgkmcnt(4)
    v_mfma_f32_32x32x8bf16_1k v[16:31], v[140:141], v[132:133], 0
    v_exp_f32 v39, v39
    v_fmac_f32 v220, v51, v83
    v_rcp_f32 v52, v52
    v_rcp_f32 v53, v53
    v_mfma_f32_32x32x16_bf16 v[16:31], v[128:131], v[212:215], v[16:31]
    v_rcp_f32 v54, v54
    v_rcp_f32 v55, v55
    s_bitcmp1_b32 s35, 4
    s_cbranch_scc1 L_fl_b1_1
L_bk_b1_1:
    v_exp_f32 v40, v40
    v_fmac_f32 v220, v52, v84
    v_mfma_f32_32x32x16_bf16 v[16:31], v[112:115], v[148:151], v[16:31]
    v_exp_f32 v41, v41
    v_fmac_f32 v220, v53, v85
    v_exp_f32 v42, v42
    v_fmac_f32 v220, v54, v86
    s_waitcnt lgkmcnt(0)
    v_mfma_f32_32x32x16_bf16 v[16:31], v[116:119], v[152:155], v[16:31]
    buffer_load_dwordx4 v[234:235], s[8:11], 0 idxen offen offset:3072 lds
    v_exp_f32 v43, v43
    v_fmac_f32 v220, v55, v87
    v_rcp_f32 v56, v56
    v_mfma_f32_32x32x16_bf16 v[16:31], v[120:123], v[156:159], v[16:31]
    v_rcp_f32 v57, v57
    v_rcp_f32 v58, v58
    v_rcp_f32 v59, v59
    s_bitcmp1_b32 s35, 8
    s_cbranch_scc1 L_fl_b1_2
L_bk_b1_2:
    v_exp_f32 v44, v44
    v_fmac_f32 v220, v56, v88
    v_mfma_f32_32x32x16_bf16 v[16:31], v[124:127], v[160:163], v[16:31]
    v_exp_f32 v45, v45
    v_fmac_f32 v220, v57, v89
    v_exp_f32 v46, v46
    v_fmac_f32 v220, v58, v90
    v_exp_f32 v47, v47
    v_fmac_f32 v220, v59, v91
    v_rcp_f32 v60, v60
    v_rcp_f32 v61, v61
    v_mfma_f32_32x32x8bf16_1k v[64:79], v[144:145], v[146:147], v[32:47]
    v_rcp_f32 v62, v62
    s_add_u32 m0, s38, 9216
    v_rcp_f32 v63, v63
    buffer_load_dwordx4 v[236:237], s[56:59], 0 idxen offen lds
    s_bitcmp1_b32 s35, 12
    s_cbranch_scc1 L_fl_b1_3
L_bk_b1_3:
    v_fmac_f32 v220, v60, v92
    v_fmac_f32 v220, v61, v93
    v_fmac_f32 v220, v62, v94
    v_fmac_f32 v220, v63, v95
    v_add_u32 v249, 256, v249
    v_add_u32 v250, 256, v250
    v_add_u32 v251, 32, v251
    s_sub_u32 s30, s30, 1
    s_cmp_gt_u32 s30, 2
    s_cbranch_scc1 L_u0
    s_mov_b32 s10, 0
    s_mov_b32 s58, 0
    s_cmp_eq_u32 s30, 0
    s_cbranch_scc0 L_u0
    s_nop 1
    v_rcp_f32 v64, v64
    v_rcp_f32 v65, v65
    v_rcp_f32 v66, v66
    v_rcp_f32 v67, v67
    v_rcp_f32 v68, v68
    v_rcp_f32 v69, v69
    v_rcp_f32 v70, v70
    v_rcp_f32 v71, v71
    s_bitcmp1_b32 s35, 0
    s_cbranch_scc1 L_fl_d1_0
L_bk_d1_0:
    v_fmac_f32 v221, v64, v96
    v_fmac_f32 v221, v65, v97
    v_fmac_f32 v221, v66, v98
    v_fmac_f32 v221, v67, v99
    v_rcp_f32 v72, v72
    v_rcp_f32 v73, v73
    v_rcp_f32 v74, v74
    v_rcp_f32 v75, v75
    s_bitcmp1_b32 s35, 4
    s_cbranch_scc1 L_fl_d1_1
L_bk_d1_1:
    v_fmac_f32 v221, v68, v100
    v_fmac_f32 v221, v69, v101
    v_fmac_f32 v221, v70, v102
    v_fmac_f32 v221, v71, v103
    v_rcp_f32 v76, v76
    v_rcp_f32 v77, v77
    v_rcp_f32 v78, v78
    v_rcp_f32 v79, v79
    s_bitcmp1_b32 s35, 8
    s_cbranch_scc1 L_fl_d1_2
L_bk_d1_2:
    v_fmac_f32 v221, v72, v104
    v_fmac_f32 v221, v73, v105
    v_fmac_f32 v221, v74, v106
    v_fmac_f32 v221, v75, v107
    s_bitcmp1_b32 s35, 12
    s_cbranch_scc1 L_fl_d1_3
L_bk_d1_3:
    v_fmac_f32 v221, v76, v108
    v_fmac_f32 v221, v77, v109
    v_fmac_f32 v221, v78, v110
    v_fmac_f32 v221, v79, v111
    s_branch L_flush
L_tail0:
    s_mov_b32 s10, 0
    s_mov_b32 s58, 0
    s_cmp_eq_u32 s30, 0
    s_cbranch_scc0 L_u1
    s_nop 1
    v_rcp_f32 v64, v64
    v_rcp_f32 v65, v65
    v_rcp_f32 v66, v66
    v_rcp_f32 v67, v67
    v_rcp_f32 v68, v68
    v_rcp_f32 v69, v69
    v_rcp_f32 v70, v70
    v_rcp_f32 v71, v71
    s_bitcmp1_b32 s34, 0
    s_cbranch_scc1 L_fl_d0_0
L_bk_d0_0:
    v_fmac_f32 v221, v64, v96
    v_fmac_f32 v221, v65, v97
    v_fmac_f32 v221, v66, v98
    v_fmac_f32 v221, v67, v99
    v_rcp_f32 v72, v72
    v_rcp_f32 v73, v73
    v_rcp_f32 v74, v74
    v_rcp_f32 v75, v75
    s_bitcmp1_b32 s34, 4
    s_cbranch_scc1 L_fl_d0_1
L_bk_d0_1:
    v_fmac_f32 v221, v68, v100
    v_fmac_f32 v221, v69, v101
    v_fmac_f32 v221, v70, v102
    v_fmac_f32 v221, v71, v103
    v_rcp_f32 v76, v76
    v_rcp_f32 v77, v77
    v_rcp_f32 v78, v78
    v_rcp_f32 v79, v79
    s_bitcmp1_b32 s34, 8
    s_cbranch_scc1 L_fl_d0_2
L_bk_d0_2:
    v_fmac_f32 v221, v72, v104
    v_fmac_f32 v221, v73, v105
    v_fmac_f32 v221, v74, v106
    v_fmac_f32 v221, v75, v107
    s_bitcmp1_b32 s34, 12
    s_cbranch_scc1 L_fl_d0_3
L_bk_d0_3:
    v_fmac_f32 v221, v76, v108
    v_fmac_f32 v221, v77, v109
    v_fmac_f32 v221, v78, v110
    v_fmac_f32 v221, v79, v111
L_flush:
    v_cvt_f64_f32 v[224:225], v220
    v_cvt_f64_f32 v[252:253], v221
    ds_add_f64 v222, v[224:225]
    ds_add_f64 v223, v[252:253] offset:256
L_rend:
    s_mul_i32 s46, s28, 5120
    s_add_u32 s46, s46, 115328
    v_mul_u32_u24 v2, 640, v14
    v_lshl_add_u32 v2, v15, 4, v2
    v_add_u32 v2, s46, v2
    s_lshl_b32 s46, s28, 18
    s_lshl_b32 s47, s29, 7
    s_add_u32 s46, s46, s47
    v_lshlrev_b32 v48, 15, v14
    v_lshl_add_u32 v48, v15, 2, v48
    v_add_u32 v48, s46, v48
    s_mov_b32 s46, 0xbfb8aa3b
    v_add_u32 v49, 0x10000, v48
    v_add_u32 v50, 0x20000, v48
    v_add_u32 v51, 0x30000, v48
    s_waitcnt vmcnt(0) lgkmcnt(0)
    s_barrier
    s_add_u32 s39, s39, 1
    s_cmp_lt_u32 s39, s50
    s_cbranch_scc1 L_fb_round
    s_cmp_eq_u32 s28, 7
    s_cbranch_scc1 L_fin
    ds_read_b128 v[16:19], v2 offset:0
    ds_read_b128 v[20:23], v2 offset:1280
    ds_read_b128 v[24:27], v2 offset:2560
    ds_read_b128 v[28:31], v2 offset:3840
    s_waitcnt lgkmcnt(3)
    v_cvt_f32_f64 v32, v[16:17]
    v_cvt_f32_f64 v33, v[18:19]
    s_waitcnt lgkmcnt(2)
    v_cvt_f32_f64 v34, v[20:21]
    v_cvt_f32_f64 v35, v[22:23]
    s_waitcnt lgkmcnt(1)
    v_cvt_f32_f64 v36, v[24:25]
    v_cvt_f32_f64 v37, v[26:27]
    s_waitcnt lgkmcnt(0)
    v_cvt_f32_f64 v38, v[28:29]
    v_cvt_f32_f64 v39, v[30:31]
    v_mul_f32 v40, s46, v32
    v_mul_f32 v41, s46, v33
    v_mul_f32 v42, s46, v34
    v_mul_f32 v43, s46, v35
    v_mul_f32 v44, s46, v36
    v_mul_f32 v45, s46, v37
    v_mul_f32 v46, s46, v38
    v_mul_f32 v47, s46, v39
    v_exp_f32 v40, v40
    v_exp_f32 v41, v41
    v_exp_f32 v42, v42
    v_exp_f32 v43, v43
    v_exp_f32 v44, v44
    v_exp_f32 v45, v45
    v_exp_f32 v46, v46
    v_exp_f32 v47, v47
    v_add_f32 v40, 1.0, v40
    v_add_f32 v41, 1.0, v41
    v_add_f32 v42, 1.0, v42
    v_add_f32 v43, 1.0, v43
    v_add_f32 v44, 1.0, v44
    v_add_f32 v45, 1.0, v45
    v_add_f32 v46, 1.0, v46
    v_add_f32 v47, 1.0, v47
    v_rcp_f32 v40, v40
    v_rcp_f32 v41, v41
    v_rcp_f32 v42, v42
    v_rcp_f32 v43, v43
    v_rcp_f32 v44, v44
    v_rcp_f32 v45, v45
    v_rcp_f32 v46, v46
    v_rcp_f32 v47, v47
    v_mul_f32 v40, v32, v40
    v_mul_f32 v41, v33, v41
    v_cvt_pk_bf16_f32 v40, v40, v41
    buffer_store_dword v40, v48, s[24:27], 0 offen
    v_mul_f32 v42, v34, v42
    v_mul_f32 v43, v35, v43
    v_cvt_pk_bf16_f32 v42, v42, v43
    buffer_store_dword v42, v49, s[24:27], 0 offen
    v_mul_f32 v44, v36, v44
    v_mul_f32 v45, v37, v45
    v_cvt_pk_bf16_f32 v44, v44, v45
    buffer_store_dword v44, v50, s[24:27], 0 offen
    v_mul_f32 v46, v38, v46
    v_mul_f32 v47, v39, v47
    v_cvt_pk_bf16_f32 v46, v46, v47
    buffer_store_dword v46, v51, s[24:27], 0 offen
L_fin:
    s_endpgm
L_fl_a0_0:
    s_bfe_i32 exec_lo, s36, 0x10000
    s_bfe_i32 exec_hi, s37, 0x10000
    v_cvt_f64_f32 v[224:225], v221
    v_mov_b32 v221, 0
    ds_add_f64 v223, v[224:225] offset:256
    v_add_u32_dpp v223, v227, v239 row_newbcast:0 row_mask:0xf bank_mask:0xf
    s_mov_b64 exec, -1
    s_branch L_bk_a0_0
L_fl_a0_1:
    s_bfe_i32 exec_lo, s36, 0x10004
    s_bfe_i32 exec_hi, s37, 0x10004
    v_cvt_f64_f32 v[224:225], v221
    v_mov_b32 v221, 0
    ds_add_f64 v223, v[224:225] offset:256
    v_add_u32_dpp v223, v227, v239 row_newbcast:4 row_mask:0xf bank_mask:0xf
    s_mov_b64 exec, -1
    s_branch L_bk_a0_1
L_fl_a0_2:
    s_bfe_i32 exec_lo, s36, 0x10008
    s_bfe_i32 exec_hi, s37, 0x10008
    v_cvt_f64_f32 v[224:225], v221
    v_mov_b32 v221, 0
    ds_add_f64 v223, v[224:225] offset:256
    v_add_u32_dpp v223, v227, v239 row_newbcast:8 row_mask:0xf bank_mask:0xf
    s_mov_b64 exec, -1
    s_branch L_bk_a0_2
L_fl_a0_3:
    s_bfe_i32 exec_lo, s36, 0x1000c
    s_bfe_i32 exec_hi, s37, 0x1000c
    v_cvt_f64_f32 v[224:225], v221
    v_mov_b32 v221, 0
    ds_add_f64 v223, v[224:225] offset:256
    v_add_u32_dpp v223, v227, v239 row_newbcast:12 row_mask:0xf bank_mask:0xf
    s_mov_b64 exec, -1
    s_branch L_bk_a0_3
L_fl_a1_0:
    s_bfe_i32 exec_lo, s32, 0x10000
    s_bfe_i32 exec_hi, s33, 0x10000
    v_cvt_f64_f32 v[224:225], v221
    v_mov_b32 v221, 0
    ds_add_f64 v223, v[224:225] offset:256
    v_add_u32_dpp v223, v226, v239 row_newbcast:0 row_mask:0xf bank_mask:0xf
    s_mov_b64 exec, -1
    s_branch L_bk_a1_0
L_fl_a1_1:
    s_bfe_i32 exec_lo, s32, 0x10004
    s_bfe_i32 exec_hi, s33, 0x10004
    v_cvt_f64_f32 v[224:225], v221
    v_mov_b32 v221, 0
    ds_add_f64 v223, v[224:225] offset:256
    v_add_u32_dpp v223, v226, v239 row_newbcast:4 row_mask:0xf bank_mask:0xf
    s_mov_b64 exec, -1
    s_branch L_bk_a1_1
L_fl_a1_2:
    s_bfe_i32 exec_lo, s32, 0x10008
    s_bfe_i32 exec_hi, s33, 0x10008
    v_cvt_f64_f32 v[224:225], v221
    v_mov_b32 v221, 0
    ds_add_f64 v223, v[224:225] offset:256
    v_add_u32_dpp v223, v226, v239 row_newbcast:8 row_mask:0xf bank_mask:0xf
    s_mov_b64 exec, -1
    s_branch L_bk_a1_2
L_fl_a1_3:
    s_bfe_i32 exec_lo, s32, 0x1000c
    s_bfe_i32 exec_hi, s33, 0x1000c
    v_cvt_f64_f32 v[224:225], v221
    v_mov_b32 v221, 0
    ds_add_f64 v223, v[224:225] offset:256
    v_add_u32_dpp v223, v226, v239 row_newbcast:12 row_mask:0xf bank_mask:0xf
    s_mov_b64 exec, -1
    s_branch L_bk_a1_3
L_fl_b0_0:
    s_bfe_i32 exec_lo, s32, 0x10000
    s_bfe_i32 exec_hi, s33, 0x10000
    v_cvt_f64_f32 v[224:225], v220
    v_mov_b32 v220, 0
    ds_add_f64 v222, v[224:225] offset:0
    v_add_u32_dpp v222, v226, v239 row_newbcast:0 row_mask:0xf bank_mask:0xf
    s_mov_b64 exec, -1
    s_branch L_bk_b0_0
L_fl_b0_1:
    s_bfe_i32 exec_lo, s32, 0x10004
    s_bfe_i32 exec_hi, s33, 0x10004
    v_cvt_f64_f32 v[224:225], v220
    v_mov_b32 v220, 0
    ds_add_f64 v222, v[224:225] offset:0
    v_add_u32_dpp v222, v226, v239 row_newbcast:4 row_mask:0xf bank_mask:0xf
    s_mov_b64 exec, -1
    s_branch L_bk_b0_1
L_fl_b0_2:
    s_bfe_i32 exec_lo, s32, 0x10008
    s_bfe_i32 exec_hi, s33, 0x10008
    v_cvt_f64_f32 v[224:225], v220
    v_mov_b32 v220, 0
    ds_add_f64 v222, v[224:225] offset:0
    v_add_u32_dpp v222, v226, v239 row_newbcast:8 row_mask:0xf bank_mask:0xf
    s_mov_b64 exec, -1
    s_branch L_bk_b0_2
L_fl_b0_3:
    s_bfe_i32 exec_lo, s32, 0x1000c
    s_bfe_i32 exec_hi, s33, 0x1000c
    v_cvt_f64_f32 v[224:225], v220
    v_mov_b32 v220, 0
    ds_add_f64 v222, v[224:225] offset:0
    v_add_u32_dpp v222, v226, v239 row_newbcast:12 row_mask:0xf bank_mask:0xf
    s_mov_b64 exec, -1
    s_branch L_bk_b0_3
L_fl_b1_0:
    s_bfe_i32 exec_lo, s36, 0x10000
    s_bfe_i32 exec_hi, s37, 0x10000
    v_cvt_f64_f32 v[224:225], v220
    v_mov_b32 v220, 0
    ds_add_f64 v222, v[224:225] offset:0
    v_add_u32_dpp v222, v227, v239 row_newbcast:0 row_mask:0xf bank_mask:0xf
    s_mov_b64 exec, -1
    s_branch L_bk_b1_0
L_fl_b1_1:
    s_bfe_i32 exec_lo, s36, 0x10004
    s_bfe_i32 exec_hi, s37, 0x10004
    v_cvt_f64_f32 v[224:225], v220
    v_mov_b32 v220, 0
    ds_add_f64 v222, v[224:225] offset:0
    v_add_u32_dpp v222, v227, v239 row_newbcast:4 row_mask:0xf bank_mask:0xf
    s_mov_b64 exec, -1
    s_branch L_bk_b1_1
L_fl_b1_2:
    s_bfe_i32 exec_lo, s36, 0x10008
    s_bfe_i32 exec_hi, s37, 0x10008
    v_cvt_f64_f32 v[224:225], v220
    v_mov_b32 v220, 0
    ds_add_f64 v222, v[224:225] offset:0
    v_add_u32_dpp v222, v227, v239 row_newbcast:8 row_mask:0xf bank_mask:0xf
    s_mov_b64 exec, -1
    s_branch L_bk_b1_2
L_fl_b1_3:
    s_bfe_i32 exec_lo, s36, 0x1000c
    s_bfe_i32 exec_hi, s37, 0x1000c
    v_cvt_f64_f32 v[224:225], v220
    v_mov_b32 v220, 0
    ds_add_f64 v222, v[224:225] offset:0
    v_add_u32_dpp v222, v227, v239 row_newbcast:12 row_mask:0xf bank_mask:0xf
    s_mov_b64 exec, -1
    s_branch L_bk_b1_3
L_fl_d0_0:
    s_bfe_i32 exec_lo, s32, 0x10000
    s_bfe_i32 exec_hi, s33, 0x10000
    v_cvt_f64_f32 v[224:225], v221
    v_mov_b32 v221, 0
    ds_add_f64 v223, v[224:225] offset:256
    v_add_u32_dpp v223, v226, v239 row_newbcast:0 row_mask:0xf bank_mask:0xf
    s_mov_b64 exec, -1
    s_branch L_bk_d0_0
L_fl_d0_1:
    s_bfe_i32 exec_lo, s32, 0x10004
    s_bfe_i32 exec_hi, s33, 0x10004
    v_cvt_f64_f32 v[224:225], v221
    v_mov_b32 v221, 0
    ds_add_f64 v223, v[224:225] offset:256
    v_add_u32_dpp v223, v226, v239 row_newbcast:4 row_mask:0xf bank_mask:0xf
    s_mov_b64 exec, -1
    s_branch L_bk_d0_1
L_fl_d0_2:
    s_bfe_i32 exec_lo, s32, 0x10008
    s_bfe_i32 exec_hi, s33, 0x10008
    v_cvt_f64_f32 v[224:225], v221
    v_mov_b32 v221, 0
    ds_add_f64 v223, v[224:225] offset:256
    v_add_u32_dpp v223, v226, v239 row_newbcast:8 row_mask:0xf bank_mask:0xf
    s_mov_b64 exec, -1
    s_branch L_bk_d0_2
L_fl_d0_3:
    s_bfe_i32 exec_lo, s32, 0x1000c
    s_bfe_i32 exec_hi, s33, 0x1000c
    v_cvt_f64_f32 v[224:225], v221
    v_mov_b32 v221, 0
    ds_add_f64 v223, v[224:225] offset:256
    v_add_u32_dpp v223, v226, v239 row_newbcast:12 row_mask:0xf bank_mask:0xf
    s_mov_b64 exec, -1
    s_branch L_bk_d0_3
L_fl_d1_0:
    s_bfe_i32 exec_lo, s36, 0x10000
    s_bfe_i32 exec_hi, s37, 0x10000
    v_cvt_f64_f32 v[224:225], v221
    v_mov_b32 v221, 0
    ds_add_f64 v223, v[224:225] offset:256
    v_add_u32_dpp v223, v227, v239 row_newbcast:0 row_mask:0xf bank_mask:0xf
    s_mov_b64 exec, -1
    s_branch L_bk_d1_0
L_fl_d1_1:
    s_bfe_i32 exec_lo, s36, 0x10004
    s_bfe_i32 exec_hi, s37, 0x10004
    v_cvt_f64_f32 v[224:225], v221
    v_mov_b32 v221, 0
    ds_add_f64 v223, v[224:225] offset:256
    v_add_u32_dpp v223, v227, v239 row_newbcast:4 row_mask:0xf bank_mask:0xf
    s_mov_b64 exec, -1
    s_branch L_bk_d1_1
L_fl_d1_2:
    s_bfe_i32 exec_lo, s36, 0x10008
    s_bfe_i32 exec_hi, s37, 0x10008
    v_cvt_f64_f32 v[224:225], v221
    v_mov_b32 v221, 0
    ds_add_f64 v223, v[224:225] offset:256
    v_add_u32_dpp v223, v227, v239 row_newbcast:8 row_mask:0xf bank_mask:0xf
    s_mov_b64 exec, -1
    s_branch L_bk_d1_2
L_fl_d1_3:
    s_bfe_i32 exec_lo, s36, 0x1000c
    s_bfe_i32 exec_hi, s37, 0x1000c
    v_cvt_f64_f32 v[224:225], v221
    v_mov_b32 v221, 0
    ds_add_f64 v223, v[224:225] offset:256
    v_add_u32_dpp v223, v227, v239 row_newbcast:12 row_mask:0xf bank_mask:0xf
    s_mov_b64 exec, -1
    s_branch L_bk_d1_3
L_fb_enter:
    ds_max_u32 v11, v3 offset:516
    s_mov_b32 s40, 1
    s_waitcnt lgkmcnt(0)
    s_barrier
    ds_read_b32 v2, v11 offset:516
    s_waitcnt lgkmcnt(0)
    v_readfirstlane_b32 s46, v2
    s_add_u32 s46, s46, 11
    s_mul_i32 s46, s46, 5462
    s_lshr_b32 s50, s46, 16
L_fb_round:
    s_cmp_lg_u32 s28, 0
    s_cbranch_scc1 L_fb_nz
    ds_write_b32 v12, v11 offset:0
L_fb_nz:
    s_mul_i32 s46, s39, 12
    v_mul_u32_u24 v6, 6, v9
    v_add_u32 v6, s46, v6
    v_sub_u32 v7, v3, v6
    v_max_i32 v7, 0, v7
    v_min_u32 v7, 6, v7
    v_add_u32 v6, v6, v5
    v_lshlrev_b32 v8, 2, v6
    v_cmpx_lt_u32 vcc, 0, v7
    s_cbranch_execz L_ld_r
    buffer_load_dwordx4 v[16:19], v8, s[16:19], 0 offen offset:0
    v_cmpx_lt_u32 vcc, 4, v7
    s_cbranch_execz L_ld_r
    buffer_load_dwordx4 v[20:23], v8, s[16:19], 0 offen offset:16
L_ld_r:
    s_mov_b64 exec, -1
    s_waitcnt vmcnt(0) lgkmcnt(0)
    s_barrier
    s_branch L_count
K2_end:
    s_endpgm
.section .rodata,"a"
.p2align 6
.amdhsa_kernel bin_kernel
  .amdhsa_next_free_vgpr 48
  .amdhsa_next_free_sgpr 48
  .amdhsa_accum_offset 48
  .amdhsa_group_segment_fixed_size 0
  .amdhsa_kernarg_size 80
  .amdhsa_user_sgpr_count 2
  .amdhsa_user_sgpr_kernarg_segment_ptr 1
  .amdhsa_system_sgpr_workgroup_id_x 1
  .amdhsa_float_denorm_mode_32 3
.end_amdhsa_kernel
.p2align 6
.amdhsa_kernel gather_scatter__edge_featured_mpnn_egc__graph_kernel
  .amdhsa_next_free_vgpr 256
  .amdhsa_next_free_sgpr 62
  .amdhsa_accum_offset 256
  .amdhsa_group_segment_fixed_size 0
  .amdhsa_kernarg_size 80
  .amdhsa_user_sgpr_count 2
  .amdhsa_user_sgpr_kernarg_segment_ptr 1
  .amdhsa_system_sgpr_workgroup_id_x 1
  .amdhsa_float_denorm_mode_32 3
.end_amdhsa_kernel
```
